```python
import torch

def _softmax(x, axis=-1):
    return torch.softmax(x, dim=axis)
def _gelu(x):
    return torch.nn.functional.gelu(x, approximate="tanh")
def _silu(x):
    return torch.nn.functional.silu(x)
def _sigmoid(x):
    return torch.sigmoid(x)
def _layernorm(x, axis=-1, eps=1e-5):
    m = x.mean(dim=axis, keepdim=True)
    v = x.var(dim=axis, keepdim=True, unbiased=False)
    return (x - m) / torch.sqrt(v + eps)
def _scatter_add(tgt, idx, src, axis=0):
    return tgt.clone().index_add_(axis, idx, src)
def _segment_sum(src, seg, n):
    out = torch.zeros((n,) + src.shape[1:], dtype=src.dtype)
    return out.index_add_(0, seg, src)
def _pad(x, pw):
    flat = tuple(v for pair in reversed(pw) for v in pair)
    return torch.nn.functional.pad(x, flat)

kernel_name = 'standalone__gqa_block_cached__near_ridge'

def setup_inputs():

    _w = (lambda a: (lambda t: t.to(torch.bfloat16) if t.is_floating_point() else t)(torch.as_tensor(a)))
    B, Sq, D = 8, 256, 512
    Hq, Hkv, Sk, Dh = 32, 32, 1024, 128
    assert Hq % Hkv == 0, (Hq, Hkv)
    return {
        "x": _w((lambda *s: torch.randn(*s, dtype=torch.bfloat16) * 0.8)(B, Sq, D)),
        "k_cache": _w((lambda *s: torch.randn(*s, dtype=torch.bfloat16) * 0.8)(B, Hkv, Sk, Dh)),
        "v_cache": _w((lambda *s: torch.randn(*s, dtype=torch.bfloat16) * 0.05)(B, Hkv, Sk, Dh)),
        "wq": _w((lambda *s: torch.randn(*s, dtype=torch.bfloat16) * 0.8)(D, Hq * Dh) * (D ** -0.5)),
        "wo": _w((lambda *s: torch.randn(*s, dtype=torch.bfloat16) * 0.05)(Hq * Dh, D) * ((Hq * Dh) ** -0.5)),
    }

def reference(x, k_cache, v_cache, wq, wo):
    B, Sq, D = x.shape
    Hq, Dh = 32, 128
    Hkv = k_cache.shape[1]
    rep = Hq // Hkv
    q = (lambda x, *d: x.permute(*d))((x @ wq).reshape(B, Sq, Hq, Dh), 0, 2, 1, 3)
    k = (lambda x, n, axis: torch.repeat_interleave(x, n, dim=axis))(k_cache, rep, axis=1)
    v = (lambda x, n, axis: torch.repeat_interleave(x, n, dim=axis))(v_cache, rep, axis=1)
    scores = torch.einsum("bhqd,bhkd->bhqk", q, k) * (Dh ** -0.5)
    p = _softmax(scores, axis=-1)
    o = torch.einsum("bhqk,bhkd->bhqd", p, v)
    return (lambda x, *d: x.permute(*d))(o, 0, 2, 1, 3).reshape(B, Sq, Hq * Dh) @ wo
```

```asm
; @launch kernel=attn_kernel grid=(256,1,1) block=(512,1,1) lds=163840
; @launch kernel=oproj_kernel grid=(256,1,1) block=(512,1,1) lds=131072
.amdgcn_target "amdgcn-amd-amdhsa--gfx950"
.text
.globl attn_kernel
.p2align 8
.type attn_kernel,@function
attn_kernel:
    s_cmp_ge_u32 s2, 256
    s_cbranch_scc1 K1_done
    s_load_dwordx8 s[32:39], s[0:1], 0
    s_load_dwordx2 s[40:41], s[0:1], 56
    s_load_dwordx2 s[48:49], s[0:1], 32
    v_and_b32 v1, 63, v0
    v_lshrrev_b32 v6, 6, v0
    s_nop 0
    v_readfirstlane_b32 s24, v6
    v_and_b32 v2, 31, v1
    v_lshrrev_b32 v3, 5, v1
    v_and_b32 v4, 15, v1
    v_lshrrev_b32 v5, 4, v1
    s_waitcnt lgkmcnt(0)
    s_lshl_b32 s30, s2, 18
    s_add_u32 s34, s34, s30
    s_addc_u32 s35, s35, 0
    s_add_u32 s36, s36, s30
    s_addc_u32 s37, s37, 0
    s_mov_b32 s12, s32
    s_mov_b32 s13, s33
    s_mov_b32 s14, 2097152
    s_mov_b32 s15, 0x00020000
    s_mov_b32 s4, s34
    s_mov_b32 s5, s35
    s_mov_b32 s6, 262144
    s_mov_b32 s7, 0x00020000
    s_mov_b32 s8, s36
    s_mov_b32 s9, s37
    s_mov_b32 s10, 262144
    s_mov_b32 s11, 0x00020000
    s_mov_b32 s16, s38
    s_mov_b32 s17, s39
    s_mov_b32 s18, 4194304
    s_mov_b32 s19, 0x00020000
    s_mov_b32 s20, s40
    s_mov_b32 s21, s41
    s_mov_b32 s22, 20971520
    s_mov_b32 s23, 0x00020000
    s_mov_b32 s52, s48
    s_mov_b32 s53, s49
    s_mov_b32 s54, 4194304
    s_mov_b32 s55, 0x00020000
    s_lshl_b32 s25, s24, 11
    s_mov_b32 s26, 0
    s_mov_b32 s42, 0
    v_and_b32 v6, 15, v2
    v_xor_b32 v6, v6, v3
    v_lshlrev_b32 v7, 8, v2
    v_xor_b32 v8, 0, v6
    v_lshl_add_u32 v10, v8, 4, v7
    v_add_u32 v18, 0x10000, v10
    v_xor_b32 v8, 2, v6
    v_lshl_add_u32 v11, v8, 4, v7
    v_add_u32 v19, 0x10000, v11
    v_xor_b32 v8, 4, v6
    v_lshl_add_u32 v12, v8, 4, v7
    v_add_u32 v20, 0x10000, v12
    v_xor_b32 v8, 6, v6
    v_lshl_add_u32 v13, v8, 4, v7
    v_add_u32 v21, 0x10000, v13
    v_xor_b32 v8, 8, v6
    v_lshl_add_u32 v14, v8, 4, v7
    v_add_u32 v22, 0x10000, v14
    v_xor_b32 v8, 10, v6
    v_lshl_add_u32 v15, v8, 4, v7
    v_add_u32 v23, 0x10000, v15
    v_xor_b32 v8, 12, v6
    v_lshl_add_u32 v16, v8, 4, v7
    v_add_u32 v24, 0x10000, v16
    v_xor_b32 v8, 14, v6
    v_lshl_add_u32 v17, v8, 4, v7
    v_add_u32 v25, 0x10000, v17
    v_lshrrev_b32 v6, 2, v4
    v_lshl_add_u32 v7, v3, 2, v6
    v_lshlrev_b32 v7, 8, v7
    v_and_b32 v8, 1, v5
    v_lshlrev_b32 v8, 5, v8
    v_add_u32 v7, v7, v8
    v_and_b32 v8, 3, v4
    v_lshlrev_b32 v8, 3, v8
    v_add_u32 v7, v7, v8
    v_xor_b32 v8, 0, v6
    v_lshl_add_u32 v26, v8, 6, v7
    v_add_u32 v30, 0x10000, v26
    v_lshl_add_u32 v240, v3, 10, v26
    v_add_u32 v244, 0x10000, v240
    v_xor_b32 v8, 1, v6
    v_lshl_add_u32 v27, v8, 6, v7
    v_add_u32 v31, 0x10000, v27
    v_lshl_add_u32 v241, v3, 10, v27
    v_add_u32 v245, 0x10000, v241
    v_xor_b32 v8, 2, v6
    v_lshl_add_u32 v28, v8, 6, v7
    v_add_u32 v32, 0x10000, v28
    v_lshl_add_u32 v242, v3, 10, v28
    v_add_u32 v246, 0x10000, v242
    v_xor_b32 v8, 3, v6
    v_lshl_add_u32 v29, v8, 6, v7
    v_add_u32 v33, 0x10000, v29
    v_lshl_add_u32 v243, v3, 10, v29
    v_add_u32 v247, 0x10000, v243
    s_and_b32 s30, s24, 1
    s_lshl_b32 s30, s30, 3
    s_lshl_b32 s31, s24, 3
    v_add_u32 v6, s30, v5
    v_xor_b32 v6, v6, v4
    v_add_u32 v7, s31, v5
    v_lshlrev_b32 v7, 8, v7
    v_lshl_add_u32 v34, v6, 4, v7
    v_add_u32 v6, s30, v5
    v_add_u32 v6, 4, v6
    v_xor_b32 v6, v6, v4
    v_add_u32 v7, s31, v5
    v_add_u32 v7, 4, v7
    v_lshlrev_b32 v7, 8, v7
    v_lshl_add_u32 v35, v6, 4, v7
    v_lshlrev_b32 v6, 2, v5
    v_xor_b32 v6, v6, v4
    v_add_u32 v7, s31, v5
    v_lshlrev_b32 v8, 8, v7
    v_lshl_add_u32 v36, v6, 4, v8
    s_and_b32 s30, s2, 31
    s_lshl_b32 s30, s30, 8
    v_lshlrev_b32 v8, 13, v7
    v_lshl_add_u32 v248, v6, 4, v8
    v_add_u32 v248, s30, v248
    v_add_u32 v249, 0x8000, v248
    s_lshr_b32 s30, s2, 5
    s_lshl_b32 s30, s30, 8
    s_lshl_b32 s31, s24, 5
    s_add_u32 s30, s30, s31
    v_add_u32 v6, s30, v2
    v_lshlrev_b32 v7, 10, v6
    v_lshl_add_u32 v43, v3, 4, v7
    s_lshr_b32 s30, s2, 5
    s_lshl_b32 s30, s30, 3
    s_add_u32 s30, s30, s24
    s_lshl_b32 s30, s30, 18
    s_and_b32 s31, s2, 31
    s_lshl_b32 s31, s31, 13
    s_add_u32 s30, s30, s31
    v_lshlrev_b32 v44, 4, v1
    v_add_u32 v44, s30, v44
    v_lshrrev_b32 v7, 3, v1
    s_lshr_b32 s30, s2, 5
    s_lshl_b32 s30, s30, 8
    s_lshl_b32 s31, s24, 5
    s_add_u32 s30, s30, s31
    v_add_u32 v7, s30, v7
    v_lshlrev_b32 v7, 10, v7
    v_and_b32 v8, 7, v1
    v_xor_b32 v8, v8, v5
    v_lshl_add_u32 v184, v8, 4, v7
    v_xor_b32 v185, 64, v184
    v_lshrrev_b32 v8, 1, v2
    v_and_b32 v8, 7, v8
    v_xor_b32 v8, v8, v3
    v_lshlrev_b32 v7, 7, v2
    s_lshl_b32 s46, s24, 12
    v_add_u32 v7, s46, v7
    v_add_u32 v7, 65536, v7
    v_xor_b32 v9, 0, v8
    v_lshl_add_u32 v176, v9, 4, v7
    v_add_u32 v180, 0x10000, v176
    v_xor_b32 v9, 2, v8
    v_lshl_add_u32 v177, v9, 4, v7
    v_add_u32 v181, 0x10000, v177
    v_xor_b32 v9, 4, v8
    v_lshl_add_u32 v178, v9, 4, v7
    v_add_u32 v182, 0x10000, v178
    v_xor_b32 v9, 6, v8
    v_lshl_add_u32 v179, v9, 4, v7
    v_add_u32 v183, 0x10000, v179
    v_lshlrev_b32 v6, 4, v1
    v_add_u32 v6, s25, v6
    s_lshl_b32 s30, s2, 14
    s_add_u32 m0, s25, 49152
    s_nop 0
    buffer_load_dwordx4 v6, s[52:55], s30 offen lds
    buffer_load_dwordx4 v6, s[52:55], s30 offen offset:1024 lds
    s_add_u32 m0, s46, 65536
    s_mov_b32 s30, 0
    buffer_load_dwordx4 v184, s[12:15], s30 offen lds
    s_add_u32 m0, s46, 66560
    s_mov_b32 s30, 8192
    buffer_load_dwordx4 v185, s[12:15], s30 offen lds
    s_add_u32 m0, s46, 67584
    s_mov_b32 s30, 16384
    buffer_load_dwordx4 v184, s[12:15], s30 offen lds
    s_add_u32 m0, s46, 68608
    s_mov_b32 s30, 24576
    buffer_load_dwordx4 v185, s[12:15], s30 offen lds
    s_add_u32 m0, s25, 0
    s_mov_b32 s30, 0
    buffer_load_dwordx4 v248, s[16:19], s30 offen lds
    s_add_u32 m0, s25, 1024
    s_nop 0
    buffer_load_dwordx4 v249, s[16:19], s30 offen lds
    s_add_u32 m0, s46, 98304
    s_mov_b32 s30, 128
    buffer_load_dwordx4 v184, s[12:15], s30 offen lds
    s_add_u32 m0, s46, 99328
    s_mov_b32 s30, 8320
    buffer_load_dwordx4 v185, s[12:15], s30 offen lds
    s_add_u32 m0, s46, 100352
    s_mov_b32 s30, 16512
    buffer_load_dwordx4 v184, s[12:15], s30 offen lds
    s_add_u32 m0, s46, 101376
    s_mov_b32 s30, 24704
    buffer_load_dwordx4 v185, s[12:15], s30 offen lds
    s_add_u32 m0, s25, 32768
    s_mov_b32 s30, 524288
    buffer_load_dwordx4 v248, s[16:19], s30 offen lds
    s_add_u32 m0, s25, 33792
    s_nop 0
    buffer_load_dwordx4 v249, s[16:19], s30 offen lds
    s_add_u32 m0, s46, 131072
    s_mov_b32 s30, 256
    buffer_load_dwordx4 v184, s[12:15], s30 offen lds
    s_add_u32 m0, s46, 132096
    s_mov_b32 s30, 8448
    buffer_load_dwordx4 v185, s[12:15], s30 offen lds
    s_add_u32 m0, s46, 133120
    s_mov_b32 s30, 16640
    buffer_load_dwordx4 v184, s[12:15], s30 offen lds
    s_add_u32 m0, s46, 134144
    s_mov_b32 s30, 24832
    buffer_load_dwordx4 v185, s[12:15], s30 offen lds
    s_add_u32 m0, s25, 16384
    s_mov_b32 s30, 1048576
    buffer_load_dwordx4 v248, s[16:19], s30 offen lds
    s_add_u32 m0, s25, 17408
    s_nop 0
    buffer_load_dwordx4 v249, s[16:19], s30 offen lds
    v_lshrrev_b32 v6, 2, v4
    v_lshl_add_u32 v6, v3, 3, v6
    v_lshlrev_b32 v6, 10, v6
    v_and_b32 v7, 1, v5
    v_lshl_add_u32 v6, v7, 5, v6
    v_and_b32 v7, 3, v4
    v_lshl_add_u32 v6, v7, 3, v6
    s_lshl_b32 s30, s24, 7
    v_add_u32 v6, s30, v6
    s_lshl_b32 s30, s24, 19
    s_lshl_b32 s31, s2, 10
    s_add_u32 s30, s30, s31
    s_add_u32 s30, s30, 16777216
    v_lshlrev_b32 v7, 4, v1
    v_add_u32 v7, s30, v7
    v_add_u32 v8, 0x40000, v7
    s_waitcnt vmcnt(18)
    s_barrier
    ds_read_b64_tr_b16 v[192:193], v6 offset:49152
    ds_read_b64_tr_b16 v[194:195], v6 offset:53248
    ds_read_b64_tr_b16 v[196:197], v6 offset:49216
    ds_read_b64_tr_b16 v[198:199], v6 offset:53312
    s_waitcnt lgkmcnt(0)
    buffer_store_dwordx4 v[192:195], v7, s[20:23], 0 offen
    buffer_store_dwordx4 v[196:199], v8, s[20:23], 0 offen
    v_mov_b32 v80, 0
    v_mov_b32 v81, 0
    v_mov_b32 v82, 0
    v_mov_b32 v83, 0
    v_mov_b32 v84, 0
    v_mov_b32 v85, 0
    v_mov_b32 v86, 0
    v_mov_b32 v87, 0
    v_mov_b32 v88, 0
    v_mov_b32 v89, 0
    v_mov_b32 v90, 0
    v_mov_b32 v91, 0
    v_mov_b32 v92, 0
    v_mov_b32 v93, 0
    v_mov_b32 v94, 0
    v_mov_b32 v95, 0
    v_mov_b32 v96, 0
    v_mov_b32 v97, 0
    v_mov_b32 v98, 0
    v_mov_b32 v99, 0
    v_mov_b32 v100, 0
    v_mov_b32 v101, 0
    v_mov_b32 v102, 0
    v_mov_b32 v103, 0
    v_mov_b32 v104, 0
    v_mov_b32 v105, 0
    v_mov_b32 v106, 0
    v_mov_b32 v107, 0
    v_mov_b32 v108, 0
    v_mov_b32 v109, 0
    v_mov_b32 v110, 0
    v_mov_b32 v111, 0
    v_mov_b32 v112, 0
    v_mov_b32 v113, 0
    v_mov_b32 v114, 0
    v_mov_b32 v115, 0
    v_mov_b32 v116, 0
    v_mov_b32 v117, 0
    v_mov_b32 v118, 0
    v_mov_b32 v119, 0
    v_mov_b32 v120, 0
    v_mov_b32 v121, 0
    v_mov_b32 v122, 0
    v_mov_b32 v123, 0
    v_mov_b32 v124, 0
    v_mov_b32 v125, 0
    v_mov_b32 v126, 0
    v_mov_b32 v127, 0
    v_mov_b32 v128, 0
    v_mov_b32 v129, 0
    v_mov_b32 v130, 0
    v_mov_b32 v131, 0
    v_mov_b32 v132, 0
    v_mov_b32 v133, 0
    v_mov_b32 v134, 0
    v_mov_b32 v135, 0
    v_mov_b32 v136, 0
    v_mov_b32 v137, 0
    v_mov_b32 v138, 0
    v_mov_b32 v139, 0
    v_mov_b32 v140, 0
    v_mov_b32 v141, 0
    v_mov_b32 v142, 0
    v_mov_b32 v143, 0
    s_waitcnt vmcnt(16)
    ds_read_b128 v[144:147], v176 offset:0
    ds_read_b128 v[148:151], v177 offset:0
    ds_read_b128 v[152:155], v178 offset:0
    ds_read_b128 v[156:159], v179 offset:0
    s_waitcnt vmcnt(14)
    s_barrier
    s_waitcnt lgkmcnt(0)
    s_add_u32 m0, s25, 49152
    s_mov_b32 s30, 1572864
    buffer_load_dwordx4 v248, s[16:19], s30 offen lds
    s_add_u32 m0, s25, 50176
    s_nop 0
    buffer_load_dwordx4 v249, s[16:19], s30 offen lds
    s_add_u32 m0, s46, 65536
    s_mov_b32 s30, 384
    buffer_load_dwordx4 v184, s[12:15], s30 offen lds
    s_add_u32 m0, s46, 66560
    s_mov_b32 s30, 8576
    buffer_load_dwordx4 v185, s[12:15], s30 offen lds
    s_add_u32 m0, s46, 67584
    s_mov_b32 s30, 16768
    buffer_load_dwordx4 v184, s[12:15], s30 offen lds
    s_add_u32 m0, s46, 68608
    s_mov_b32 s30, 24960
    buffer_load_dwordx4 v185, s[12:15], s30 offen lds
    ds_read_b64_tr_b16 v[224:225], v240 offset:0
    ds_read_b64_tr_b16 v[226:227], v240 offset:1024
    ds_read_b64_tr_b16 v[228:229], v241 offset:0
    ds_read_b64_tr_b16 v[230:231], v241 offset:1024
    ds_read_b64_tr_b16 v[232:233], v242 offset:0
    ds_read_b64_tr_b16 v[234:235], v242 offset:1024
    ds_read_b64_tr_b16 v[236:237], v243 offset:0
    ds_read_b64_tr_b16 v[238:239], v243 offset:1024
    s_waitcnt lgkmcnt(6)
    v_mfma_f32_32x32x16_bf16 v[80:95], v[224:227], v[144:147], v[80:95]
    ds_read_b64_tr_b16 v[224:225], v240 offset:4096
    ds_read_b64_tr_b16 v[226:227], v240 offset:5120
    s_waitcnt lgkmcnt(6)
    v_mfma_f32_32x32x16_bf16 v[96:111], v[228:231], v[144:147], v[96:111]
    ds_read_b64_tr_b16 v[228:229], v241 offset:4096
    ds_read_b64_tr_b16 v[230:231], v241 offset:5120
    s_waitcnt lgkmcnt(6)
    v_mfma_f32_32x32x16_bf16 v[112:127], v[232:235], v[144:147], v[112:127]
    ds_read_b64_tr_b16 v[232:233], v242 offset:4096
    ds_read_b64_tr_b16 v[234:235], v242 offset:5120
    s_waitcnt lgkmcnt(6)
    v_mfma_f32_32x32x16_bf16 v[128:143], v[236:239], v[144:147], v[128:143]
    ds_read_b64_tr_b16 v[236:237], v243 offset:4096
    ds_read_b64_tr_b16 v[238:239], v243 offset:5120
    s_waitcnt lgkmcnt(6)
    v_mfma_f32_32x32x16_bf16 v[80:95], v[224:227], v[148:151], v[80:95]
    ds_read_b64_tr_b16 v[224:225], v240 offset:8192
    ds_read_b64_tr_b16 v[226:227], v240 offset:9216
    s_waitcnt lgkmcnt(6)
    v_mfma_f32_32x32x16_bf16 v[96:111], v[228:231], v[148:151], v[96:111]
    ds_read_b64_tr_b16 v[228:229], v241 offset:8192
    ds_read_b64_tr_b16 v[230:231], v241 offset:9216
    s_waitcnt lgkmcnt(6)
    v_mfma_f32_32x32x16_bf16 v[112:127], v[232:235], v[148:151], v[112:127]
    ds_read_b64_tr_b16 v[232:233], v242 offset:8192
    ds_read_b64_tr_b16 v[234:235], v242 offset:9216
    s_waitcnt lgkmcnt(6)
    v_mfma_f32_32x32x16_bf16 v[128:143], v[236:239], v[148:151], v[128:143]
    ds_read_b64_tr_b16 v[236:237], v243 offset:8192
    ds_read_b64_tr_b16 v[238:239], v243 offset:9216
    s_waitcnt lgkmcnt(6)
    v_mfma_f32_32x32x16_bf16 v[80:95], v[224:227], v[152:155], v[80:95]
    ds_read_b64_tr_b16 v[224:225], v240 offset:12288
    ds_read_b64_tr_b16 v[226:227], v240 offset:13312
    s_waitcnt lgkmcnt(6)
    v_mfma_f32_32x32x16_bf16 v[96:111], v[228:231], v[152:155], v[96:111]
    ds_read_b64_tr_b16 v[228:229], v241 offset:12288
    ds_read_b64_tr_b16 v[230:231], v241 offset:13312
    s_waitcnt vmcnt(16)
    ds_read_b128 v[160:163], v176 offset:32768
    ds_read_b128 v[164:167], v177 offset:32768
    ds_read_b128 v[168:171], v178 offset:32768
    ds_read_b128 v[172:175], v179 offset:32768
    s_waitcnt lgkmcnt(10)
    v_mfma_f32_32x32x16_bf16 v[112:127], v[232:235], v[152:155], v[112:127]
    ds_read_b64_tr_b16 v[232:233], v242 offset:12288
    ds_read_b64_tr_b16 v[234:235], v242 offset:13312
    s_waitcnt lgkmcnt(10)
    v_mfma_f32_32x32x16_bf16 v[128:143], v[236:239], v[152:155], v[128:143]
    ds_read_b64_tr_b16 v[236:237], v243 offset:12288
    ds_read_b64_tr_b16 v[238:239], v243 offset:13312
    s_waitcnt lgkmcnt(10)
    v_mfma_f32_32x32x16_bf16 v[80:95], v[224:227], v[156:159], v[80:95]
    s_waitcnt lgkmcnt(8)
    v_mfma_f32_32x32x16_bf16 v[96:111], v[228:231], v[156:159], v[96:111]
    s_waitcnt lgkmcnt(2)
    v_mfma_f32_32x32x16_bf16 v[112:127], v[232:235], v[156:159], v[112:127]
    s_waitcnt lgkmcnt(0)
    v_mfma_f32_32x32x16_bf16 v[128:143], v[236:239], v[156:159], v[128:143]
    s_waitcnt vmcnt(14)
    s_barrier
    s_waitcnt lgkmcnt(4)
    s_add_u32 m0, s25, 0
    s_mov_b32 s30, 2097152
    buffer_load_dwordx4 v248, s[16:19], s30 offen lds
    s_add_u32 m0, s25, 1024
    s_nop 0
    buffer_load_dwordx4 v249, s[16:19], s30 offen lds
    s_add_u32 m0, s46, 98304
    s_mov_b32 s30, 512
    buffer_load_dwordx4 v184, s[12:15], s30 offen lds
    s_add_u32 m0, s46, 99328
    s_mov_b32 s30, 8704
    buffer_load_dwordx4 v185, s[12:15], s30 offen lds
    s_add_u32 m0, s46, 100352
    s_mov_b32 s30, 16896
    buffer_load_dwordx4 v184, s[12:15], s30 offen lds
    s_add_u32 m0, s46, 101376
    s_mov_b32 s30, 25088
    buffer_load_dwordx4 v185, s[12:15], s30 offen lds
    ds_read_b64_tr_b16 v[224:225], v240 offset:32768
    ds_read_b64_tr_b16 v[226:227], v240 offset:33792
    ds_read_b64_tr_b16 v[228:229], v241 offset:32768
    ds_read_b64_tr_b16 v[230:231], v241 offset:33792
    ds_read_b64_tr_b16 v[232:233], v242 offset:32768
    ds_read_b64_tr_b16 v[234:235], v242 offset:33792
    ds_read_b64_tr_b16 v[236:237], v243 offset:32768
    ds_read_b64_tr_b16 v[238:239], v243 offset:33792
    s_waitcnt lgkmcnt(6)
    v_mfma_f32_32x32x16_bf16 v[80:95], v[224:227], v[160:163], v[80:95]
    ds_read_b64_tr_b16 v[224:225], v240 offset:36864
    ds_read_b64_tr_b16 v[226:227], v240 offset:37888
    s_waitcnt lgkmcnt(6)
    v_mfma_f32_32x32x16_bf16 v[96:111], v[228:231], v[160:163], v[96:111]
    ds_read_b64_tr_b16 v[228:229], v241 offset:36864
    ds_read_b64_tr_b16 v[230:231], v241 offset:37888
    s_waitcnt lgkmcnt(6)
    v_mfma_f32_32x32x16_bf16 v[112:127], v[232:235], v[160:163], v[112:127]
    ds_read_b64_tr_b16 v[232:233], v242 offset:36864
    ds_read_b64_tr_b16 v[234:235], v242 offset:37888
    s_waitcnt lgkmcnt(6)
    v_mfma_f32_32x32x16_bf16 v[128:143], v[236:239], v[160:163], v[128:143]
    ds_read_b64_tr_b16 v[236:237], v243 offset:36864
    ds_read_b64_tr_b16 v[238:239], v243 offset:37888
    s_waitcnt lgkmcnt(6)
    v_mfma_f32_32x32x16_bf16 v[80:95], v[224:227], v[164:167], v[80:95]
    ds_read_b64_tr_b16 v[224:225], v240 offset:40960
    ds_read_b64_tr_b16 v[226:227], v240 offset:41984
    s_waitcnt lgkmcnt(6)
    v_mfma_f32_32x32x16_bf16 v[96:111], v[228:231], v[164:167], v[96:111]
    ds_read_b64_tr_b16 v[228:229], v241 offset:40960
    ds_read_b64_tr_b16 v[230:231], v241 offset:41984
    s_waitcnt lgkmcnt(6)
    v_mfma_f32_32x32x16_bf16 v[112:127], v[232:235], v[164:167], v[112:127]
    ds_read_b64_tr_b16 v[232:233], v242 offset:40960
    ds_read_b64_tr_b16 v[234:235], v242 offset:41984
    s_waitcnt lgkmcnt(6)
    v_mfma_f32_32x32x16_bf16 v[128:143], v[236:239], v[164:167], v[128:143]
    ds_read_b64_tr_b16 v[236:237], v243 offset:40960
    ds_read_b64_tr_b16 v[238:239], v243 offset:41984
    s_waitcnt lgkmcnt(6)
    v_mfma_f32_32x32x16_bf16 v[80:95], v[224:227], v[168:171], v[80:95]
    ds_read_b64_tr_b16 v[224:225], v240 offset:45056
    ds_read_b64_tr_b16 v[226:227], v240 offset:46080
    s_waitcnt lgkmcnt(6)
    v_mfma_f32_32x32x16_bf16 v[96:111], v[228:231], v[168:171], v[96:111]
    ds_read_b64_tr_b16 v[228:229], v241 offset:45056
    ds_read_b64_tr_b16 v[230:231], v241 offset:46080
    s_waitcnt vmcnt(16)
    ds_read_b128 v[144:147], v180 offset:0
    ds_read_b128 v[148:151], v181 offset:0
    ds_read_b128 v[152:155], v182 offset:0
    ds_read_b128 v[156:159], v183 offset:0
    s_waitcnt lgkmcnt(10)
    v_mfma_f32_32x32x16_bf16 v[112:127], v[232:235], v[168:171], v[112:127]
    ds_read_b64_tr_b16 v[232:233], v242 offset:45056
    ds_read_b64_tr_b16 v[234:235], v242 offset:46080
    s_waitcnt lgkmcnt(10)
    v_mfma_f32_32x32x16_bf16 v[128:143], v[236:239], v[168:171], v[128:143]
    ds_read_b64_tr_b16 v[236:237], v243 offset:45056
    ds_read_b64_tr_b16 v[238:239], v243 offset:46080
    s_waitcnt lgkmcnt(10)
    v_mfma_f32_32x32x16_bf16 v[80:95], v[224:227], v[172:175], v[80:95]
    s_waitcnt lgkmcnt(8)
    v_mfma_f32_32x32x16_bf16 v[96:111], v[228:231], v[172:175], v[96:111]
    s_waitcnt lgkmcnt(2)
    v_mfma_f32_32x32x16_bf16 v[112:127], v[232:235], v[172:175], v[112:127]
    s_waitcnt lgkmcnt(0)
    v_mfma_f32_32x32x16_bf16 v[128:143], v[236:239], v[172:175], v[128:143]
    s_waitcnt vmcnt(14)
    s_barrier
    s_waitcnt lgkmcnt(4)
    s_add_u32 m0, s25, 32768
    s_mov_b32 s30, 2621440
    buffer_load_dwordx4 v248, s[16:19], s30 offen lds
    s_add_u32 m0, s25, 33792
    s_nop 0
    buffer_load_dwordx4 v249, s[16:19], s30 offen lds
    s_add_u32 m0, s46, 131072
    s_mov_b32 s30, 640
    buffer_load_dwordx4 v184, s[12:15], s30 offen lds
    s_add_u32 m0, s46, 132096
    s_mov_b32 s30, 8832
    buffer_load_dwordx4 v185, s[12:15], s30 offen lds
    s_add_u32 m0, s46, 133120
    s_mov_b32 s30, 17024
    buffer_load_dwordx4 v184, s[12:15], s30 offen lds
    s_add_u32 m0, s46, 134144
    s_mov_b32 s30, 25216
    buffer_load_dwordx4 v185, s[12:15], s30 offen lds
    ds_read_b64_tr_b16 v[224:225], v240 offset:16384
    ds_read_b64_tr_b16 v[226:227], v240 offset:17408
    ds_read_b64_tr_b16 v[228:229], v241 offset:16384
    ds_read_b64_tr_b16 v[230:231], v241 offset:17408
    ds_read_b64_tr_b16 v[232:233], v242 offset:16384
    ds_read_b64_tr_b16 v[234:235], v242 offset:17408
    ds_read_b64_tr_b16 v[236:237], v243 offset:16384
    ds_read_b64_tr_b16 v[238:239], v243 offset:17408
    s_waitcnt lgkmcnt(6)
    v_mfma_f32_32x32x16_bf16 v[80:95], v[224:227], v[144:147], v[80:95]
    ds_read_b64_tr_b16 v[224:225], v240 offset:20480
    ds_read_b64_tr_b16 v[226:227], v240 offset:21504
    s_waitcnt lgkmcnt(6)
    v_mfma_f32_32x32x16_bf16 v[96:111], v[228:231], v[144:147], v[96:111]
    ds_read_b64_tr_b16 v[228:229], v241 offset:20480
    ds_read_b64_tr_b16 v[230:231], v241 offset:21504
    s_waitcnt lgkmcnt(6)
    v_mfma_f32_32x32x16_bf16 v[112:127], v[232:235], v[144:147], v[112:127]
    ds_read_b64_tr_b16 v[232:233], v242 offset:20480
    ds_read_b64_tr_b16 v[234:235], v242 offset:21504
    s_waitcnt lgkmcnt(6)
    v_mfma_f32_32x32x16_bf16 v[128:143], v[236:239], v[144:147], v[128:143]
    ds_read_b64_tr_b16 v[236:237], v243 offset:20480
    ds_read_b64_tr_b16 v[238:239], v243 offset:21504
    s_waitcnt lgkmcnt(6)
    v_mfma_f32_32x32x16_bf16 v[80:95], v[224:227], v[148:151], v[80:95]
    ds_read_b64_tr_b16 v[224:225], v240 offset:24576
    ds_read_b64_tr_b16 v[226:227], v240 offset:25600
    s_waitcnt lgkmcnt(6)
    v_mfma_f32_32x32x16_bf16 v[96:111], v[228:231], v[148:151], v[96:111]
    ds_read_b64_tr_b16 v[228:229], v241 offset:24576
    ds_read_b64_tr_b16 v[230:231], v241 offset:25600
    s_waitcnt lgkmcnt(6)
    v_mfma_f32_32x32x16_bf16 v[112:127], v[232:235], v[148:151], v[112:127]
    ds_read_b64_tr_b16 v[232:233], v242 offset:24576
    ds_read_b64_tr_b16 v[234:235], v242 offset:25600
    s_waitcnt lgkmcnt(6)
    v_mfma_f32_32x32x16_bf16 v[128:143], v[236:239], v[148:151], v[128:143]
    ds_read_b64_tr_b16 v[236:237], v243 offset:24576
    ds_read_b64_tr_b16 v[238:239], v243 offset:25600
    s_waitcnt lgkmcnt(6)
    v_mfma_f32_32x32x16_bf16 v[80:95], v[224:227], v[152:155], v[80:95]
    ds_read_b64_tr_b16 v[224:225], v240 offset:28672
    ds_read_b64_tr_b16 v[226:227], v240 offset:29696
    s_waitcnt lgkmcnt(6)
    v_mfma_f32_32x32x16_bf16 v[96:111], v[228:231], v[152:155], v[96:111]
    ds_read_b64_tr_b16 v[228:229], v241 offset:28672
    ds_read_b64_tr_b16 v[230:231], v241 offset:29696
    s_waitcnt vmcnt(12)
    ds_read_b128 v[160:163], v176 offset:0
    ds_read_b128 v[164:167], v177 offset:0
    ds_read_b128 v[168:171], v178 offset:0
    ds_read_b128 v[172:175], v179 offset:0
    s_waitcnt lgkmcnt(10)
    v_mfma_f32_32x32x16_bf16 v[112:127], v[232:235], v[152:155], v[112:127]
    ds_read_b64_tr_b16 v[232:233], v242 offset:28672
    ds_read_b64_tr_b16 v[234:235], v242 offset:29696
    s_waitcnt lgkmcnt(10)
    v_mfma_f32_32x32x16_bf16 v[128:143], v[236:239], v[152:155], v[128:143]
    ds_read_b64_tr_b16 v[236:237], v243 offset:28672
    ds_read_b64_tr_b16 v[238:239], v243 offset:29696
    s_waitcnt lgkmcnt(10)
    v_mfma_f32_32x32x16_bf16 v[80:95], v[224:227], v[156:159], v[80:95]
    s_waitcnt lgkmcnt(8)
    v_mfma_f32_32x32x16_bf16 v[96:111], v[228:231], v[156:159], v[96:111]
    s_waitcnt lgkmcnt(2)
    v_mfma_f32_32x32x16_bf16 v[112:127], v[232:235], v[156:159], v[112:127]
    s_waitcnt lgkmcnt(0)
    v_mfma_f32_32x32x16_bf16 v[128:143], v[236:239], v[156:159], v[128:143]
    s_waitcnt vmcnt(16)
    s_barrier
    s_waitcnt lgkmcnt(4)
    s_add_u32 m0, s25, 16384
    s_mov_b32 s30, 3145728
    buffer_load_dwordx4 v248, s[16:19], s30 offen lds
    s_add_u32 m0, s25, 17408
    s_nop 0
    buffer_load_dwordx4 v249, s[16:19], s30 offen lds
    s_add_u32 m0, s46, 65536
    s_mov_b32 s30, 768
    buffer_load_dwordx4 v184, s[12:15], s30 offen lds
    s_add_u32 m0, s46, 66560
    s_mov_b32 s30, 8960
    buffer_load_dwordx4 v185, s[12:15], s30 offen lds
    s_add_u32 m0, s46, 67584
    s_mov_b32 s30, 17152
    buffer_load_dwordx4 v184, s[12:15], s30 offen lds
    s_add_u32 m0, s46, 68608
    s_mov_b32 s30, 25344
    buffer_load_dwordx4 v185, s[12:15], s30 offen lds
    ds_read_b64_tr_b16 v[224:225], v240 offset:49152
    ds_read_b64_tr_b16 v[226:227], v240 offset:50176
    ds_read_b64_tr_b16 v[228:229], v241 offset:49152
    ds_read_b64_tr_b16 v[230:231], v241 offset:50176
    ds_read_b64_tr_b16 v[232:233], v242 offset:49152
    ds_read_b64_tr_b16 v[234:235], v242 offset:50176
    ds_read_b64_tr_b16 v[236:237], v243 offset:49152
    ds_read_b64_tr_b16 v[238:239], v243 offset:50176
    s_waitcnt lgkmcnt(6)
    v_mfma_f32_32x32x16_bf16 v[80:95], v[224:227], v[160:163], v[80:95]
    ds_read_b64_tr_b16 v[224:225], v240 offset:53248
    ds_read_b64_tr_b16 v[226:227], v240 offset:54272
    s_waitcnt lgkmcnt(6)
    v_mfma_f32_32x32x16_bf16 v[96:111], v[228:231], v[160:163], v[96:111]
    ds_read_b64_tr_b16 v[228:229], v241 offset:53248
    ds_read_b64_tr_b16 v[230:231], v241 offset:54272
    s_waitcnt lgkmcnt(6)
    v_mfma_f32_32x32x16_bf16 v[112:127], v[232:235], v[160:163], v[112:127]
    ds_read_b64_tr_b16 v[232:233], v242 offset:53248
    ds_read_b64_tr_b16 v[234:235], v242 offset:54272
    s_waitcnt lgkmcnt(6)
    v_mfma_f32_32x32x16_bf16 v[128:143], v[236:239], v[160:163], v[128:143]
    ds_read_b64_tr_b16 v[236:237], v243 offset:53248
    ds_read_b64_tr_b16 v[238:239], v243 offset:54272
    s_waitcnt lgkmcnt(6)
    v_mfma_f32_32x32x16_bf16 v[80:95], v[224:227], v[164:167], v[80:95]
    ds_read_b64_tr_b16 v[224:225], v240 offset:57344
    ds_read_b64_tr_b16 v[226:227], v240 offset:58368
    s_waitcnt lgkmcnt(6)
    v_mfma_f32_32x32x16_bf16 v[96:111], v[228:231], v[164:167], v[96:111]
    ds_read_b64_tr_b16 v[228:229], v241 offset:57344
    ds_read_b64_tr_b16 v[230:231], v241 offset:58368
    s_waitcnt lgkmcnt(6)
    v_mfma_f32_32x32x16_bf16 v[112:127], v[232:235], v[164:167], v[112:127]
    ds_read_b64_tr_b16 v[232:233], v242 offset:57344
    ds_read_b64_tr_b16 v[234:235], v242 offset:58368
    s_waitcnt lgkmcnt(6)
    v_mfma_f32_32x32x16_bf16 v[128:143], v[236:239], v[164:167], v[128:143]
    ds_read_b64_tr_b16 v[236:237], v243 offset:57344
    ds_read_b64_tr_b16 v[238:239], v243 offset:58368
    s_waitcnt lgkmcnt(6)
    v_mfma_f32_32x32x16_bf16 v[80:95], v[224:227], v[168:171], v[80:95]
    ds_read_b64_tr_b16 v[224:225], v240 offset:61440
    ds_read_b64_tr_b16 v[226:227], v240 offset:62464
    s_waitcnt lgkmcnt(6)
    v_mfma_f32_32x32x16_bf16 v[96:111], v[228:231], v[168:171], v[96:111]
    ds_read_b64_tr_b16 v[228:229], v241 offset:61440
    ds_read_b64_tr_b16 v[230:231], v241 offset:62464
    s_waitcnt vmcnt(12)
    ds_read_b128 v[144:147], v176 offset:32768
    ds_read_b128 v[148:151], v177 offset:32768
    ds_read_b128 v[152:155], v178 offset:32768
    ds_read_b128 v[156:159], v179 offset:32768
    s_waitcnt lgkmcnt(10)
    v_mfma_f32_32x32x16_bf16 v[112:127], v[232:235], v[168:171], v[112:127]
    ds_read_b64_tr_b16 v[232:233], v242 offset:61440
    ds_read_b64_tr_b16 v[234:235], v242 offset:62464
    s_waitcnt lgkmcnt(10)
    v_mfma_f32_32x32x16_bf16 v[128:143], v[236:239], v[168:171], v[128:143]
    ds_read_b64_tr_b16 v[236:237], v243 offset:61440
    ds_read_b64_tr_b16 v[238:239], v243 offset:62464
    s_waitcnt lgkmcnt(10)
    v_mfma_f32_32x32x16_bf16 v[80:95], v[224:227], v[172:175], v[80:95]
    s_waitcnt lgkmcnt(8)
    v_mfma_f32_32x32x16_bf16 v[96:111], v[228:231], v[172:175], v[96:111]
    s_waitcnt lgkmcnt(2)
    v_mfma_f32_32x32x16_bf16 v[112:127], v[232:235], v[172:175], v[112:127]
    s_waitcnt lgkmcnt(0)
    v_mfma_f32_32x32x16_bf16 v[128:143], v[236:239], v[172:175], v[128:143]
    s_waitcnt vmcnt(16)
    s_barrier
    s_waitcnt lgkmcnt(4)
    s_add_u32 m0, s25, 49152
    s_mov_b32 s30, 3670016
    buffer_load_dwordx4 v248, s[16:19], s30 offen lds
    s_add_u32 m0, s25, 50176
    s_nop 0
    buffer_load_dwordx4 v249, s[16:19], s30 offen lds
    s_add_u32 m0, s46, 98304
    s_mov_b32 s30, 896
    buffer_load_dwordx4 v184, s[12:15], s30 offen lds
    s_add_u32 m0, s46, 99328
    s_mov_b32 s30, 9088
    buffer_load_dwordx4 v185, s[12:15], s30 offen lds
    s_add_u32 m0, s46, 100352
    s_mov_b32 s30, 17280
    buffer_load_dwordx4 v184, s[12:15], s30 offen lds
    s_add_u32 m0, s46, 101376
    s_mov_b32 s30, 25472
    buffer_load_dwordx4 v185, s[12:15], s30 offen lds
    ds_read_b64_tr_b16 v[224:225], v240 offset:0
    ds_read_b64_tr_b16 v[226:227], v240 offset:1024
    ds_read_b64_tr_b16 v[228:229], v241 offset:0
    ds_read_b64_tr_b16 v[230:231], v241 offset:1024
    ds_read_b64_tr_b16 v[232:233], v242 offset:0
    ds_read_b64_tr_b16 v[234:235], v242 offset:1024
    ds_read_b64_tr_b16 v[236:237], v243 offset:0
    ds_read_b64_tr_b16 v[238:239], v243 offset:1024
    s_waitcnt lgkmcnt(6)
    v_mfma_f32_32x32x16_bf16 v[80:95], v[224:227], v[144:147], v[80:95]
    ds_read_b64_tr_b16 v[224:225], v240 offset:4096
    ds_read_b64_tr_b16 v[226:227], v240 offset:5120
    s_waitcnt lgkmcnt(6)
    v_mfma_f32_32x32x16_bf16 v[96:111], v[228:231], v[144:147], v[96:111]
    ds_read_b64_tr_b16 v[228:229], v241 offset:4096
    ds_read_b64_tr_b16 v[230:231], v241 offset:5120
    s_waitcnt lgkmcnt(6)
    v_mfma_f32_32x32x16_bf16 v[112:127], v[232:235], v[144:147], v[112:127]
    ds_read_b64_tr_b16 v[232:233], v242 offset:4096
    ds_read_b64_tr_b16 v[234:235], v242 offset:5120
    s_waitcnt lgkmcnt(6)
    v_mfma_f32_32x32x16_bf16 v[128:143], v[236:239], v[144:147], v[128:143]
    ds_read_b64_tr_b16 v[236:237], v243 offset:4096
    ds_read_b64_tr_b16 v[238:239], v243 offset:5120
    s_waitcnt lgkmcnt(6)
    v_mfma_f32_32x32x16_bf16 v[80:95], v[224:227], v[148:151], v[80:95]
    ds_read_b64_tr_b16 v[224:225], v240 offset:8192
    ds_read_b64_tr_b16 v[226:227], v240 offset:9216
    s_waitcnt lgkmcnt(6)
    v_mfma_f32_32x32x16_bf16 v[96:111], v[228:231], v[148:151], v[96:111]
    ds_read_b64_tr_b16 v[228:229], v241 offset:8192
    ds_read_b64_tr_b16 v[230:231], v241 offset:9216
    s_waitcnt lgkmcnt(6)
    v_mfma_f32_32x32x16_bf16 v[112:127], v[232:235], v[148:151], v[112:127]
    ds_read_b64_tr_b16 v[232:233], v242 offset:8192
    ds_read_b64_tr_b16 v[234:235], v242 offset:9216
    s_waitcnt lgkmcnt(6)
    v_mfma_f32_32x32x16_bf16 v[128:143], v[236:239], v[148:151], v[128:143]
    ds_read_b64_tr_b16 v[236:237], v243 offset:8192
    ds_read_b64_tr_b16 v[238:239], v243 offset:9216
    s_waitcnt lgkmcnt(6)
    v_mfma_f32_32x32x16_bf16 v[80:95], v[224:227], v[152:155], v[80:95]
    ds_read_b64_tr_b16 v[224:225], v240 offset:12288
    ds_read_b64_tr_b16 v[226:227], v240 offset:13312
    s_waitcnt lgkmcnt(6)
    v_mfma_f32_32x32x16_bf16 v[96:111], v[228:231], v[152:155], v[96:111]
    ds_read_b64_tr_b16 v[228:229], v241 offset:12288
    ds_read_b64_tr_b16 v[230:231], v241 offset:13312
    s_waitcnt vmcnt(12)
    ds_read_b128 v[160:163], v180 offset:0
    ds_read_b128 v[164:167], v181 offset:0
    ds_read_b128 v[168:171], v182 offset:0
    ds_read_b128 v[172:175], v183 offset:0
    s_waitcnt lgkmcnt(10)
    v_mfma_f32_32x32x16_bf16 v[112:127], v[232:235], v[152:155], v[112:127]
    ds_read_b64_tr_b16 v[232:233], v242 offset:12288
    ds_read_b64_tr_b16 v[234:235], v242 offset:13312
    s_waitcnt lgkmcnt(10)
    v_mfma_f32_32x32x16_bf16 v[128:143], v[236:239], v[152:155], v[128:143]
    ds_read_b64_tr_b16 v[236:237], v243 offset:12288
    ds_read_b64_tr_b16 v[238:239], v243 offset:13312
    s_waitcnt lgkmcnt(10)
    v_mfma_f32_32x32x16_bf16 v[80:95], v[224:227], v[156:159], v[80:95]
    s_waitcnt lgkmcnt(8)
    v_mfma_f32_32x32x16_bf16 v[96:111], v[228:231], v[156:159], v[96:111]
    s_waitcnt lgkmcnt(2)
    v_mfma_f32_32x32x16_bf16 v[112:127], v[232:235], v[156:159], v[112:127]
    s_waitcnt lgkmcnt(0)
    v_mfma_f32_32x32x16_bf16 v[128:143], v[236:239], v[156:159], v[128:143]
    s_waitcnt vmcnt(16)
    s_barrier
    s_waitcnt lgkmcnt(4)
    s_add_u32 m0, s25, 0
    s_nop 0
    buffer_load_dwordx4 v34, s[4:7], s26 offen lds
    s_add_u32 m0, s25, 1024
    s_nop 0
    buffer_load_dwordx4 v35, s[4:7], s26 offen lds
    s_add_u32 s26, s26, 16384
    ds_read_b64_tr_b16 v[224:225], v240 offset:32768
    ds_read_b64_tr_b16 v[226:227], v240 offset:33792
    ds_read_b64_tr_b16 v[228:229], v241 offset:32768
    ds_read_b64_tr_b16 v[230:231], v241 offset:33792
    ds_read_b64_tr_b16 v[232:233], v242 offset:32768
    ds_read_b64_tr_b16 v[234:235], v242 offset:33792
    ds_read_b64_tr_b16 v[236:237], v243 offset:32768
    ds_read_b64_tr_b16 v[238:239], v243 offset:33792
    s_waitcnt lgkmcnt(6)
    v_mfma_f32_32x32x16_bf16 v[80:95], v[224:227], v[160:163], v[80:95]
    ds_read_b64_tr_b16 v[224:225], v240 offset:36864
    ds_read_b64_tr_b16 v[226:227], v240 offset:37888
    s_waitcnt lgkmcnt(6)
    v_mfma_f32_32x32x16_bf16 v[96:111], v[228:231], v[160:163], v[96:111]
    ds_read_b64_tr_b16 v[228:229], v241 offset:36864
    ds_read_b64_tr_b16 v[230:231], v241 offset:37888
    s_waitcnt lgkmcnt(6)
    v_mfma_f32_32x32x16_bf16 v[112:127], v[232:235], v[160:163], v[112:127]
    ds_read_b64_tr_b16 v[232:233], v242 offset:36864
    ds_read_b64_tr_b16 v[234:235], v242 offset:37888
    s_waitcnt lgkmcnt(6)
    v_mfma_f32_32x32x16_bf16 v[128:143], v[236:239], v[160:163], v[128:143]
    ds_read_b64_tr_b16 v[236:237], v243 offset:36864
    ds_read_b64_tr_b16 v[238:239], v243 offset:37888
    s_waitcnt lgkmcnt(6)
    v_mfma_f32_32x32x16_bf16 v[80:95], v[224:227], v[164:167], v[80:95]
    ds_read_b64_tr_b16 v[224:225], v240 offset:40960
    ds_read_b64_tr_b16 v[226:227], v240 offset:41984
    s_waitcnt lgkmcnt(6)
    v_mfma_f32_32x32x16_bf16 v[96:111], v[228:231], v[164:167], v[96:111]
    ds_read_b64_tr_b16 v[228:229], v241 offset:40960
    ds_read_b64_tr_b16 v[230:231], v241 offset:41984
    s_waitcnt lgkmcnt(6)
    v_mfma_f32_32x32x16_bf16 v[112:127], v[232:235], v[164:167], v[112:127]
    ds_read_b64_tr_b16 v[232:233], v242 offset:40960
    ds_read_b64_tr_b16 v[234:235], v242 offset:41984
    s_waitcnt lgkmcnt(6)
    v_mfma_f32_32x32x16_bf16 v[128:143], v[236:239], v[164:167], v[128:143]
    ds_read_b64_tr_b16 v[236:237], v243 offset:40960
    ds_read_b64_tr_b16 v[238:239], v243 offset:41984
    s_waitcnt lgkmcnt(6)
    v_mfma_f32_32x32x16_bf16 v[80:95], v[224:227], v[168:171], v[80:95]
    ds_read_b64_tr_b16 v[224:225], v240 offset:45056
    ds_read_b64_tr_b16 v[226:227], v240 offset:46080
    s_waitcnt lgkmcnt(6)
    v_mfma_f32_32x32x16_bf16 v[96:111], v[228:231], v[168:171], v[96:111]
    ds_read_b64_tr_b16 v[228:229], v241 offset:45056
    ds_read_b64_tr_b16 v[230:231], v241 offset:46080
    s_waitcnt vmcnt(8)
    ds_read_b128 v[144:147], v176 offset:0
    ds_read_b128 v[148:151], v177 offset:0
    ds_read_b128 v[152:155], v178 offset:0
    ds_read_b128 v[156:159], v179 offset:0
    s_waitcnt lgkmcnt(10)
    v_mfma_f32_32x32x16_bf16 v[112:127], v[232:235], v[168:171], v[112:127]
    ds_read_b64_tr_b16 v[232:233], v242 offset:45056
    ds_read_b64_tr_b16 v[234:235], v242 offset:46080
    s_waitcnt lgkmcnt(10)
    v_mfma_f32_32x32x16_bf16 v[128:143], v[236:239], v[168:171], v[128:143]
    ds_read_b64_tr_b16 v[236:237], v243 offset:45056
    ds_read_b64_tr_b16 v[238:239], v243 offset:46080
    s_waitcnt lgkmcnt(10)
    v_mfma_f32_32x32x16_bf16 v[80:95], v[224:227], v[172:175], v[80:95]
    s_waitcnt lgkmcnt(8)
    v_mfma_f32_32x32x16_bf16 v[96:111], v[228:231], v[172:175], v[96:111]
    s_waitcnt lgkmcnt(2)
    v_mfma_f32_32x32x16_bf16 v[112:127], v[232:235], v[172:175], v[112:127]
    s_waitcnt lgkmcnt(0)
    v_mfma_f32_32x32x16_bf16 v[128:143], v[236:239], v[172:175], v[128:143]
    s_waitcnt vmcnt(12)
    s_barrier
    s_waitcnt lgkmcnt(4)
    s_add_u32 m0, s25, 32768
    s_nop 0
    buffer_load_dwordx4 v34, s[4:7], s26 offen lds
    s_add_u32 m0, s25, 33792
    s_nop 0
    buffer_load_dwordx4 v35, s[4:7], s26 offen lds
    s_add_u32 s26, s26, 16384
    ds_read_b64_tr_b16 v[224:225], v240 offset:16384
    ds_read_b64_tr_b16 v[226:227], v240 offset:17408
    ds_read_b64_tr_b16 v[228:229], v241 offset:16384
    ds_read_b64_tr_b16 v[230:231], v241 offset:17408
    ds_read_b64_tr_b16 v[232:233], v242 offset:16384
    ds_read_b64_tr_b16 v[234:235], v242 offset:17408
    ds_read_b64_tr_b16 v[236:237], v243 offset:16384
    ds_read_b64_tr_b16 v[238:239], v243 offset:17408
    s_waitcnt lgkmcnt(6)
    v_mfma_f32_32x32x16_bf16 v[80:95], v[224:227], v[144:147], v[80:95]
    ds_read_b64_tr_b16 v[224:225], v240 offset:20480
    ds_read_b64_tr_b16 v[226:227], v240 offset:21504
    s_waitcnt lgkmcnt(6)
    v_mfma_f32_32x32x16_bf16 v[96:111], v[228:231], v[144:147], v[96:111]
    ds_read_b64_tr_b16 v[228:229], v241 offset:20480
    ds_read_b64_tr_b16 v[230:231], v241 offset:21504
    s_waitcnt lgkmcnt(6)
    v_mfma_f32_32x32x16_bf16 v[112:127], v[232:235], v[144:147], v[112:127]
    ds_read_b64_tr_b16 v[232:233], v242 offset:20480
    ds_read_b64_tr_b16 v[234:235], v242 offset:21504
    s_waitcnt lgkmcnt(6)
    v_mfma_f32_32x32x16_bf16 v[128:143], v[236:239], v[144:147], v[128:143]
    ds_read_b64_tr_b16 v[236:237], v243 offset:20480
    ds_read_b64_tr_b16 v[238:239], v243 offset:21504
    s_waitcnt lgkmcnt(6)
    v_mfma_f32_32x32x16_bf16 v[80:95], v[224:227], v[148:151], v[80:95]
    ds_read_b64_tr_b16 v[224:225], v240 offset:24576
    ds_read_b64_tr_b16 v[226:227], v240 offset:25600
    s_waitcnt lgkmcnt(6)
    v_mfma_f32_32x32x16_bf16 v[96:111], v[228:231], v[148:151], v[96:111]
    ds_read_b64_tr_b16 v[228:229], v241 offset:24576
    ds_read_b64_tr_b16 v[230:231], v241 offset:25600
    s_waitcnt lgkmcnt(6)
    v_mfma_f32_32x32x16_bf16 v[112:127], v[232:235], v[148:151], v[112:127]
    ds_read_b64_tr_b16 v[232:233], v242 offset:24576
    ds_read_b64_tr_b16 v[234:235], v242 offset:25600
    s_waitcnt lgkmcnt(6)
    v_mfma_f32_32x32x16_bf16 v[128:143], v[236:239], v[148:151], v[128:143]
    ds_read_b64_tr_b16 v[236:237], v243 offset:24576
    ds_read_b64_tr_b16 v[238:239], v243 offset:25600
    s_waitcnt lgkmcnt(6)
    v_mfma_f32_32x32x16_bf16 v[80:95], v[224:227], v[152:155], v[80:95]
    ds_read_b64_tr_b16 v[224:225], v240 offset:28672
    ds_read_b64_tr_b16 v[226:227], v240 offset:29696
    s_waitcnt lgkmcnt(6)
    v_mfma_f32_32x32x16_bf16 v[96:111], v[228:231], v[152:155], v[96:111]
    ds_read_b64_tr_b16 v[228:229], v241 offset:28672
    ds_read_b64_tr_b16 v[230:231], v241 offset:29696
    s_waitcnt vmcnt(4)
    ds_read_b128 v[160:163], v176 offset:32768
    ds_read_b128 v[164:167], v177 offset:32768
    ds_read_b128 v[168:171], v178 offset:32768
    ds_read_b128 v[172:175], v179 offset:32768
    s_waitcnt lgkmcnt(10)
    v_mfma_f32_32x32x16_bf16 v[112:127], v[232:235], v[152:155], v[112:127]
    ds_read_b64_tr_b16 v[232:233], v242 offset:28672
    ds_read_b64_tr_b16 v[234:235], v242 offset:29696
    s_waitcnt lgkmcnt(10)
    v_mfma_f32_32x32x16_bf16 v[128:143], v[236:239], v[152:155], v[128:143]
    ds_read_b64_tr_b16 v[236:237], v243 offset:28672
    ds_read_b64_tr_b16 v[238:239], v243 offset:29696
    s_waitcnt lgkmcnt(10)
    v_mfma_f32_32x32x16_bf16 v[80:95], v[224:227], v[156:159], v[80:95]
    s_waitcnt lgkmcnt(8)
    v_mfma_f32_32x32x16_bf16 v[96:111], v[228:231], v[156:159], v[96:111]
    s_waitcnt lgkmcnt(2)
    v_mfma_f32_32x32x16_bf16 v[112:127], v[232:235], v[156:159], v[112:127]
    s_waitcnt lgkmcnt(0)
    v_mfma_f32_32x32x16_bf16 v[128:143], v[236:239], v[156:159], v[128:143]
    s_waitcnt vmcnt(8)
    s_barrier
    s_waitcnt lgkmcnt(4)
    s_add_u32 m0, s25, 16384
    s_nop 0
    buffer_load_dwordx4 v36, s[8:11], s42 offen lds
    buffer_load_dwordx4 v36, s[8:11], s42 offen offset:1024 lds
    s_add_u32 s42, s42, 16384
    s_add_u32 m0, s25, 65536
    s_nop 0
    buffer_load_dwordx4 v34, s[4:7], s26 offen lds
    s_add_u32 m0, s25, 66560
    s_nop 0
    buffer_load_dwordx4 v35, s[4:7], s26 offen lds
    s_add_u32 s26, s26, 16384
    ds_read_b64_tr_b16 v[224:225], v240 offset:49152
    ds_read_b64_tr_b16 v[226:227], v240 offset:50176
    ds_read_b64_tr_b16 v[228:229], v241 offset:49152
    ds_read_b64_tr_b16 v[230:231], v241 offset:50176
    ds_read_b64_tr_b16 v[232:233], v242 offset:49152
    ds_read_b64_tr_b16 v[234:235], v242 offset:50176
    ds_read_b64_tr_b16 v[236:237], v243 offset:49152
    ds_read_b64_tr_b16 v[238:239], v243 offset:50176
    s_waitcnt lgkmcnt(6)
    v_mfma_f32_32x32x16_bf16 v[80:95], v[224:227], v[160:163], v[80:95]
    ds_read_b64_tr_b16 v[224:225], v240 offset:53248
    ds_read_b64_tr_b16 v[226:227], v240 offset:54272
    s_waitcnt lgkmcnt(6)
    v_mfma_f32_32x32x16_bf16 v[96:111], v[228:231], v[160:163], v[96:111]
    ds_read_b64_tr_b16 v[228:229], v241 offset:53248
    ds_read_b64_tr_b16 v[230:231], v241 offset:54272
    s_waitcnt lgkmcnt(6)
    v_mfma_f32_32x32x16_bf16 v[112:127], v[232:235], v[160:163], v[112:127]
    ds_read_b64_tr_b16 v[232:233], v242 offset:53248
    ds_read_b64_tr_b16 v[234:235], v242 offset:54272
    s_waitcnt lgkmcnt(6)
    v_mfma_f32_32x32x16_bf16 v[128:143], v[236:239], v[160:163], v[128:143]
    ds_read_b64_tr_b16 v[236:237], v243 offset:53248
    ds_read_b64_tr_b16 v[238:239], v243 offset:54272
    s_waitcnt lgkmcnt(6)
    v_mfma_f32_32x32x16_bf16 v[80:95], v[224:227], v[164:167], v[80:95]
    ds_read_b64_tr_b16 v[224:225], v240 offset:57344
    ds_read_b64_tr_b16 v[226:227], v240 offset:58368
    s_waitcnt lgkmcnt(6)
    v_mfma_f32_32x32x16_bf16 v[96:111], v[228:231], v[164:167], v[96:111]
    ds_read_b64_tr_b16 v[228:229], v241 offset:57344
    ds_read_b64_tr_b16 v[230:231], v241 offset:58368
    s_waitcnt lgkmcnt(6)
    v_mfma_f32_32x32x16_bf16 v[112:127], v[232:235], v[164:167], v[112:127]
    ds_read_b64_tr_b16 v[232:233], v242 offset:57344
    ds_read_b64_tr_b16 v[234:235], v242 offset:58368
    s_waitcnt lgkmcnt(6)
    v_mfma_f32_32x32x16_bf16 v[128:143], v[236:239], v[164:167], v[128:143]
    ds_read_b64_tr_b16 v[236:237], v243 offset:57344
    ds_read_b64_tr_b16 v[238:239], v243 offset:58368
    s_waitcnt lgkmcnt(6)
    v_mfma_f32_32x32x16_bf16 v[80:95], v[224:227], v[168:171], v[80:95]
    ds_read_b64_tr_b16 v[224:225], v240 offset:61440
    ds_read_b64_tr_b16 v[226:227], v240 offset:62464
    s_waitcnt lgkmcnt(6)
    v_mfma_f32_32x32x16_bf16 v[96:111], v[228:231], v[168:171], v[96:111]
    ds_read_b64_tr_b16 v[228:229], v241 offset:61440
    ds_read_b64_tr_b16 v[230:231], v241 offset:62464
    s_waitcnt lgkmcnt(6)
    v_mfma_f32_32x32x16_bf16 v[112:127], v[232:235], v[168:171], v[112:127]
    ds_read_b64_tr_b16 v[232:233], v242 offset:61440
    ds_read_b64_tr_b16 v[234:235], v242 offset:62464
    s_waitcnt lgkmcnt(6)
    v_mfma_f32_32x32x16_bf16 v[128:143], v[236:239], v[168:171], v[128:143]
    ds_read_b64_tr_b16 v[236:237], v243 offset:61440
    ds_read_b64_tr_b16 v[238:239], v243 offset:62464
    s_waitcnt lgkmcnt(6)
    v_mfma_f32_32x32x16_bf16 v[80:95], v[224:227], v[172:175], v[80:95]
    s_waitcnt lgkmcnt(4)
    v_mfma_f32_32x32x16_bf16 v[96:111], v[228:231], v[172:175], v[96:111]
    s_waitcnt lgkmcnt(2)
    v_mfma_f32_32x32x16_bf16 v[112:127], v[232:235], v[172:175], v[112:127]
    s_waitcnt lgkmcnt(0)
    v_mfma_f32_32x32x16_bf16 v[128:143], v[236:239], v[172:175], v[128:143]
    s_barrier
    s_add_u32 m0, s25, 49152
    s_nop 0
    buffer_load_dwordx4 v36, s[8:11], s42 offen lds
    buffer_load_dwordx4 v36, s[8:11], s42 offen offset:1024 lds
    s_add_u32 s42, s42, 16384
    s_mov_b32 s30, 0x3e0293ee
    v_mul_f32 v80, s30, v80
    v_mul_f32 v81, s30, v81
    v_mul_f32 v82, s30, v82
    v_mul_f32 v83, s30, v83
    v_mul_f32 v84, s30, v84
    v_mul_f32 v85, s30, v85
    v_mul_f32 v86, s30, v86
    v_mul_f32 v87, s30, v87
    v_mul_f32 v88, s30, v88
    v_mul_f32 v89, s30, v89
    v_mul_f32 v90, s30, v90
    v_mul_f32 v91, s30, v91
    v_mul_f32 v92, s30, v92
    v_mul_f32 v93, s30, v93
    v_mul_f32 v94, s30, v94
    v_mul_f32 v95, s30, v95
    v_mul_f32 v96, s30, v96
    v_mul_f32 v97, s30, v97
    v_mul_f32 v98, s30, v98
    v_mul_f32 v99, s30, v99
    v_mul_f32 v100, s30, v100
    v_mul_f32 v101, s30, v101
    v_mul_f32 v102, s30, v102
    v_mul_f32 v103, s30, v103
    v_mul_f32 v104, s30, v104
    v_mul_f32 v105, s30, v105
    v_mul_f32 v106, s30, v106
    v_mul_f32 v107, s30, v107
    v_mul_f32 v108, s30, v108
    v_mul_f32 v109, s30, v109
    v_mul_f32 v110, s30, v110
    v_mul_f32 v111, s30, v111
    v_mul_f32 v112, s30, v112
    v_mul_f32 v113, s30, v113
    v_mul_f32 v114, s30, v114
    v_mul_f32 v115, s30, v115
    v_mul_f32 v116, s30, v116
    v_mul_f32 v117, s30, v117
    v_mul_f32 v118, s30, v118
    v_mul_f32 v119, s30, v119
    v_mul_f32 v120, s30, v120
    v_mul_f32 v121, s30, v121
    v_mul_f32 v122, s30, v122
    v_mul_f32 v123, s30, v123
    v_mul_f32 v124, s30, v124
    v_mul_f32 v125, s30, v125
    v_mul_f32 v126, s30, v126
    v_mul_f32 v127, s30, v127
    v_mul_f32 v128, s30, v128
    v_mul_f32 v129, s30, v129
    v_mul_f32 v130, s30, v130
    v_mul_f32 v131, s30, v131
    v_mul_f32 v132, s30, v132
    v_mul_f32 v133, s30, v133
    v_mul_f32 v134, s30, v134
    v_mul_f32 v135, s30, v135
    v_mul_f32 v136, s30, v136
    v_mul_f32 v137, s30, v137
    v_mul_f32 v138, s30, v138
    v_mul_f32 v139, s30, v139
    v_mul_f32 v140, s30, v140
    v_mul_f32 v141, s30, v141
    v_mul_f32 v142, s30, v142
    v_mul_f32 v143, s30, v143
    v_cvt_pk_bf16_f32 v48, v80, v81
    v_cvt_pk_bf16_f32 v49, v82, v83
    v_cvt_pk_bf16_f32 v50, v84, v85
    v_cvt_pk_bf16_f32 v51, v86, v87
    s_nop 0
    v_permlane32_swap_b32 v48, v50
    v_permlane32_swap_b32 v49, v51
    v_cvt_pk_bf16_f32 v52, v88, v89
    v_cvt_pk_bf16_f32 v53, v90, v91
    v_cvt_pk_bf16_f32 v54, v92, v93
    v_cvt_pk_bf16_f32 v55, v94, v95
    s_nop 0
    v_permlane32_swap_b32 v52, v54
    v_permlane32_swap_b32 v53, v55
    v_cvt_pk_bf16_f32 v56, v96, v97
    v_cvt_pk_bf16_f32 v57, v98, v99
    v_cvt_pk_bf16_f32 v58, v100, v101
    v_cvt_pk_bf16_f32 v59, v102, v103
    s_nop 0
    v_permlane32_swap_b32 v56, v58
    v_permlane32_swap_b32 v57, v59
    v_cvt_pk_bf16_f32 v60, v104, v105
    v_cvt_pk_bf16_f32 v61, v106, v107
    v_cvt_pk_bf16_f32 v62, v108, v109
    v_cvt_pk_bf16_f32 v63, v110, v111
    s_nop 0
    v_permlane32_swap_b32 v60, v62
    v_permlane32_swap_b32 v61, v63
    v_cvt_pk_bf16_f32 v64, v112, v113
    v_cvt_pk_bf16_f32 v65, v114, v115
    v_cvt_pk_bf16_f32 v66, v116, v117
    v_cvt_pk_bf16_f32 v67, v118, v119
    s_nop 0
    v_permlane32_swap_b32 v64, v66
    v_permlane32_swap_b32 v65, v67
    v_cvt_pk_bf16_f32 v68, v120, v121
    v_cvt_pk_bf16_f32 v69, v122, v123
    v_cvt_pk_bf16_f32 v70, v124, v125
    v_cvt_pk_bf16_f32 v71, v126, v127
    s_nop 0
    v_permlane32_swap_b32 v68, v70
    v_permlane32_swap_b32 v69, v71
    v_cvt_pk_bf16_f32 v72, v128, v129
    v_cvt_pk_bf16_f32 v73, v130, v131
    v_cvt_pk_bf16_f32 v74, v132, v133
    v_cvt_pk_bf16_f32 v75, v134, v135
    s_nop 0
    v_permlane32_swap_b32 v72, v74
    v_permlane32_swap_b32 v73, v75
    v_cvt_pk_bf16_f32 v76, v136, v137
    v_cvt_pk_bf16_f32 v77, v138, v139
    v_cvt_pk_bf16_f32 v78, v140, v141
    v_cvt_pk_bf16_f32 v79, v142, v143
    s_nop 0
    v_permlane32_swap_b32 v76, v78
    v_permlane32_swap_b32 v77, v79
    v_mov_b32 v80, 0
    v_mov_b32 v81, 0
    v_mov_b32 v82, 0
    v_mov_b32 v83, 0
    v_mov_b32 v84, 0
    v_mov_b32 v85, 0
    v_mov_b32 v86, 0
    v_mov_b32 v87, 0
    v_mov_b32 v88, 0
    v_mov_b32 v89, 0
    v_mov_b32 v90, 0
    v_mov_b32 v91, 0
    v_mov_b32 v92, 0
    v_mov_b32 v93, 0
    v_mov_b32 v94, 0
    v_mov_b32 v95, 0
    v_mov_b32 v96, 0
    v_mov_b32 v97, 0
    v_mov_b32 v98, 0
    v_mov_b32 v99, 0
    v_mov_b32 v100, 0
    v_mov_b32 v101, 0
    v_mov_b32 v102, 0
    v_mov_b32 v103, 0
    v_mov_b32 v104, 0
    v_mov_b32 v105, 0
    v_mov_b32 v106, 0
    v_mov_b32 v107, 0
    v_mov_b32 v108, 0
    v_mov_b32 v109, 0
    v_mov_b32 v110, 0
    v_mov_b32 v111, 0
    v_mov_b32 v112, 0
    v_mov_b32 v113, 0
    v_mov_b32 v114, 0
    v_mov_b32 v115, 0
    v_mov_b32 v116, 0
    v_mov_b32 v117, 0
    v_mov_b32 v118, 0
    v_mov_b32 v119, 0
    v_mov_b32 v120, 0
    v_mov_b32 v121, 0
    v_mov_b32 v122, 0
    v_mov_b32 v123, 0
    v_mov_b32 v124, 0
    v_mov_b32 v125, 0
    v_mov_b32 v126, 0
    v_mov_b32 v127, 0
    v_mov_b32 v128, 0
    v_mov_b32 v129, 0
    v_mov_b32 v130, 0
    v_mov_b32 v131, 0
    v_mov_b32 v132, 0
    v_mov_b32 v133, 0
    v_mov_b32 v134, 0
    v_mov_b32 v135, 0
    v_mov_b32 v136, 0
    v_mov_b32 v137, 0
    v_mov_b32 v138, 0
    v_mov_b32 v139, 0
    v_mov_b32 v140, 0
    v_mov_b32 v141, 0
    v_mov_b32 v142, 0
    v_mov_b32 v143, 0
    v_mov_b32 v144, 0
    v_mov_b32 v145, 0
    v_mov_b32 v146, 0
    v_mov_b32 v147, 0
    v_mov_b32 v148, 0
    v_mov_b32 v149, 0
    v_mov_b32 v150, 0
    v_mov_b32 v151, 0
    v_mov_b32 v152, 0
    v_mov_b32 v153, 0
    v_mov_b32 v154, 0
    v_mov_b32 v155, 0
    v_mov_b32 v156, 0
    v_mov_b32 v157, 0
    v_mov_b32 v158, 0
    v_mov_b32 v159, 0
    v_mov_b32 v37, 0
    v_mov_b32 v39, 0
    s_mov_b32 s28, 0xff800000
    s_mov_b32 s29, 0xff800000
    s_mov_b32 s27, 0
    s_waitcnt vmcnt(8)
    s_barrier
    ds_read_b128 v[208:211], v10 offset:0
    ds_read_b128 v[212:215], v11 offset:0
    ds_read_b128 v[216:219], v12 offset:0
    ds_read_b128 v[220:223], v13 offset:0
    s_cmp_lt_u32 s24, 4
    s_cbranch_scc1 K1_h0
    s_waitcnt vmcnt(4)
    s_barrier
K1_h0:
    s_setprio 1
    s_waitcnt lgkmcnt(3)
    v_mfma_f32_32x32x16_bf16 v[160:175], v[208:211], v[48:51], v[144:159]
    ds_read_b128 v[208:211], v14 offset:0
    s_waitcnt lgkmcnt(3)
    v_mfma_f32_32x32x16_bf16 v[160:175], v[212:215], v[52:55], v[160:175]
    ds_read_b128 v[212:215], v15 offset:0
    s_waitcnt lgkmcnt(3)
    v_mfma_f32_32x32x16_bf16 v[160:175], v[216:219], v[56:59], v[160:175]
    ds_read_b128 v[216:219], v16 offset:0
    s_waitcnt lgkmcnt(3)
    v_mfma_f32_32x32x16_bf16 v[160:175], v[220:223], v[60:63], v[160:175]
    ds_read_b128 v[220:223], v17 offset:0
    s_waitcnt lgkmcnt(3)
    v_mfma_f32_32x32x16_bf16 v[160:175], v[208:211], v[64:67], v[160:175]
    ds_read_b128 v[208:211], v10 offset:8192
    s_waitcnt lgkmcnt(3)
    v_mfma_f32_32x32x16_bf16 v[160:175], v[212:215], v[68:71], v[160:175]
    ds_read_b128 v[212:215], v11 offset:8192
    s_waitcnt lgkmcnt(3)
    v_mfma_f32_32x32x16_bf16 v[160:175], v[216:219], v[72:75], v[160:175]
    ds_read_b128 v[216:219], v12 offset:8192
    s_waitcnt lgkmcnt(3)
    v_mfma_f32_32x32x16_bf16 v[160:175], v[220:223], v[76:79], v[160:175]
    ds_read_b128 v[220:223], v13 offset:8192
    s_waitcnt lgkmcnt(3)
    v_mfma_f32_32x32x16_bf16 v[176:191], v[208:211], v[48:51], v[144:159]
    ds_read_b128 v[208:211], v14 offset:8192
    s_waitcnt lgkmcnt(3)
    v_mfma_f32_32x32x16_bf16 v[176:191], v[212:215], v[52:55], v[176:191]
    ds_read_b128 v[212:215], v15 offset:8192
    s_waitcnt lgkmcnt(3)
    v_mfma_f32_32x32x16_bf16 v[176:191], v[216:219], v[56:59], v[176:191]
    ds_read_b128 v[216:219], v16 offset:8192
    s_waitcnt lgkmcnt(3)
    v_mfma_f32_32x32x16_bf16 v[176:191], v[220:223], v[60:63], v[176:191]
    ds_read_b128 v[220:223], v17 offset:8192
    s_waitcnt lgkmcnt(3)
    v_mfma_f32_32x32x16_bf16 v[176:191], v[208:211], v[64:67], v[176:191]
    s_waitcnt lgkmcnt(2)
    v_mfma_f32_32x32x16_bf16 v[176:191], v[212:215], v[68:71], v[176:191]
    s_waitcnt lgkmcnt(1)
    v_mfma_f32_32x32x16_bf16 v[176:191], v[216:219], v[72:75], v[176:191]
    s_waitcnt lgkmcnt(0)
    v_mfma_f32_32x32x16_bf16 v[176:191], v[220:223], v[76:79], v[176:191]
    s_setprio 0
    s_waitcnt vmcnt(4)
    s_barrier
    s_nop 15
K1_loop:
    s_add_u32 m0, s25, 98304
    s_nop 0
    buffer_load_dwordx4 v34, s[4:7], s26 offen lds
    s_add_u32 m0, s25, 99328
    s_nop 0
    buffer_load_dwordx4 v35, s[4:7], s26 offen lds
    s_add_u32 m0, s25, 81920
    s_nop 0
    buffer_load_dwordx4 v36, s[8:11], s42 offen lds
    buffer_load_dwordx4 v36, s[8:11], s42 offen offset:1024 lds
    s_add_u32 s26, s26, 16384
    s_add_u32 s42, s42, 16384
    v_max3_f32 v38, v160, v161, v162
    v_max3_f32 v38, v38, v163, v164
    v_max3_f32 v38, v38, v165, v166
    v_max3_f32 v38, v38, v167, v168
    v_max3_f32 v38, v38, v169, v170
    v_max3_f32 v38, v38, v171, v172
    v_max3_f32 v38, v38, v173, v174
    v_max3_f32 v38, v38, v175, v176
    v_max3_f32 v38, v38, v177, v178
    v_max3_f32 v38, v38, v179, v180
    v_max3_f32 v38, v38, v181, v182
    v_max3_f32 v38, v38, v183, v184
    v_max3_f32 v38, v38, v185, v186
    v_max3_f32 v38, v38, v187, v188
    v_max3_f32 v38, v38, v189, v190
    v_max_f32 v38, v38, v191
    v_cmp_lt_f32 vcc, s28, v38
    s_nop 4
    s_cbranch_vccz K1_nr_l0
    v_mov_b32 v6, v38
    v_mov_b32 v7, v38
    s_nop 0
    s_nop 0
    v_permlane32_swap_b32 v6, v7
    v_max_f32 v41, v6, v7
    v_max_f32 v41, s29, v41
    v_sub_f32 v42, 0, v41
    v_min_f32 v42, 0x42c80000, v42
    v_exp_f32 v42, v42
    v_sub_f32 v160, v160, v41
    v_sub_f32 v161, v161, v41
    v_sub_f32 v162, v162, v41
    v_sub_f32 v163, v163, v41
    v_sub_f32 v164, v164, v41
    v_sub_f32 v165, v165, v41
    v_sub_f32 v166, v166, v41
    v_sub_f32 v167, v167, v41
    v_sub_f32 v168, v168, v41
    v_sub_f32 v169, v169, v41
    v_sub_f32 v170, v170, v41
    v_sub_f32 v171, v171, v41
    v_sub_f32 v172, v172, v41
    v_sub_f32 v173, v173, v41
    v_sub_f32 v174, v174, v41
    v_sub_f32 v175, v175, v41
    v_sub_f32 v176, v176, v41
    v_sub_f32 v177, v177, v41
    v_sub_f32 v178, v178, v41
    v_sub_f32 v179, v179, v41
    v_sub_f32 v180, v180, v41
    v_sub_f32 v181, v181, v41
    v_sub_f32 v182, v182, v41
    v_sub_f32 v183, v183, v41
    v_sub_f32 v184, v184, v41
    v_sub_f32 v185, v185, v41
    v_sub_f32 v186, v186, v41
    v_sub_f32 v187, v187, v41
    v_sub_f32 v188, v188, v41
    v_sub_f32 v189, v189, v41
    v_sub_f32 v190, v190, v41
    v_sub_f32 v191, v191, v41
    v_sub_f32 v144, v144, v41
    v_sub_f32 v145, v145, v41
    v_sub_f32 v146, v146, v41
    v_sub_f32 v147, v147, v41
    v_sub_f32 v148, v148, v41
    v_sub_f32 v149, v149, v41
    v_sub_f32 v150, v150, v41
    v_sub_f32 v151, v151, v41
    v_sub_f32 v152, v152, v41
    v_sub_f32 v153, v153, v41
    v_sub_f32 v154, v154, v41
    v_sub_f32 v155, v155, v41
    v_sub_f32 v156, v156, v41
    v_sub_f32 v157, v157, v41
    v_sub_f32 v158, v158, v41
    v_sub_f32 v159, v159, v41
    v_mul_f32 v37, v37, v42
    v_mul_f32 v39, v39, v42
    v_mul_f32 v80, v80, v42
    v_mul_f32 v81, v81, v42
    v_mul_f32 v82, v82, v42
    v_mul_f32 v83, v83, v42
    v_mul_f32 v84, v84, v42
    v_mul_f32 v85, v85, v42
    v_mul_f32 v86, v86, v42
    v_mul_f32 v87, v87, v42
    v_mul_f32 v88, v88, v42
    v_mul_f32 v89, v89, v42
    v_mul_f32 v90, v90, v42
    v_mul_f32 v91, v91, v42
    v_mul_f32 v92, v92, v42
    v_mul_f32 v93, v93, v42
    v_mul_f32 v94, v94, v42
    v_mul_f32 v95, v95, v42
    v_mul_f32 v96, v96, v42
    v_mul_f32 v97, v97, v42
    v_mul_f32 v98, v98, v42
    v_mul_f32 v99, v99, v42
    v_mul_f32 v100, v100, v42
    v_mul_f32 v101, v101, v42
    v_mul_f32 v102, v102, v42
    v_mul_f32 v103, v103, v42
    v_mul_f32 v104, v104, v42
    v_mul_f32 v105, v105, v42
    v_mul_f32 v106, v106, v42
    v_mul_f32 v107, v107, v42
    v_mul_f32 v108, v108, v42
    v_mul_f32 v109, v109, v42
    v_mul_f32 v110, v110, v42
    v_mul_f32 v111, v111, v42
    v_mul_f32 v112, v112, v42
    v_mul_f32 v113, v113, v42
    v_mul_f32 v114, v114, v42
    v_mul_f32 v115, v115, v42
    v_mul_f32 v116, v116, v42
    v_mul_f32 v117, v117, v42
    v_mul_f32 v118, v118, v42
    v_mul_f32 v119, v119, v42
    v_mul_f32 v120, v120, v42
    v_mul_f32 v121, v121, v42
    v_mul_f32 v122, v122, v42
    v_mul_f32 v123, v123, v42
    v_mul_f32 v124, v124, v42
    v_mul_f32 v125, v125, v42
    v_mul_f32 v126, v126, v42
    v_mul_f32 v127, v127, v42
    v_mul_f32 v128, v128, v42
    v_mul_f32 v129, v129, v42
    v_mul_f32 v130, v130, v42
    v_mul_f32 v131, v131, v42
    v_mul_f32 v132, v132, v42
    v_mul_f32 v133, v133, v42
    v_mul_f32 v134, v134, v42
    v_mul_f32 v135, v135, v42
    v_mul_f32 v136, v136, v42
    v_mul_f32 v137, v137, v42
    v_mul_f32 v138, v138, v42
    v_mul_f32 v139, v139, v42
    v_mul_f32 v140, v140, v42
    v_mul_f32 v141, v141, v42
    v_mul_f32 v142, v142, v42
    v_mul_f32 v143, v143, v42
    s_nop 15
K1_nr_l0:
    s_mov_b32 s28, 0x41000000
    s_mov_b32 s29, 0
    v_exp_f32 v160, v160
    v_exp_f32 v161, v161
    v_exp_f32 v162, v162
    v_exp_f32 v163, v163
    v_add_f32 v37, v37, v160
    v_add_f32 v39, v39, v161
    v_cvt_pk_bf16_f32 v192, v160, v161
    v_exp_f32 v164, v164
    v_exp_f32 v165, v165
    v_add_f32 v37, v37, v162
    v_add_f32 v39, v39, v163
    v_cvt_pk_bf16_f32 v193, v162, v163
    v_exp_f32 v166, v166
    v_exp_f32 v167, v167
    v_add_f32 v37, v37, v164
    v_add_f32 v39, v39, v165
    v_cvt_pk_bf16_f32 v194, v164, v165
    v_exp_f32 v168, v168
    v_exp_f32 v169, v169
    v_add_f32 v37, v37, v166
    v_add_f32 v39, v39, v167
    v_cvt_pk_bf16_f32 v195, v166, v167
    v_exp_f32 v170, v170
    v_exp_f32 v171, v171
    v_add_f32 v37, v37, v168
    v_add_f32 v39, v39, v169
    v_cvt_pk_bf16_f32 v196, v168, v169
    v_exp_f32 v172, v172
    v_exp_f32 v173, v173
    v_add_f32 v37, v37, v170
    v_add_f32 v39, v39, v171
    v_cvt_pk_bf16_f32 v197, v170, v171
    v_exp_f32 v174, v174
    v_exp_f32 v175, v175
    v_add_f32 v37, v37, v172
    v_add_f32 v39, v39, v173
    v_cvt_pk_bf16_f32 v198, v172, v173
    v_exp_f32 v176, v176
    v_exp_f32 v177, v177
    v_add_f32 v37, v37, v174
    v_add_f32 v39, v39, v175
    v_cvt_pk_bf16_f32 v199, v174, v175
    v_exp_f32 v178, v178
    v_exp_f32 v179, v179
    v_add_f32 v37, v37, v176
    v_add_f32 v39, v39, v177
    v_cvt_pk_bf16_f32 v200, v176, v177
    v_exp_f32 v180, v180
    v_exp_f32 v181, v181
    v_add_f32 v37, v37, v178
    v_add_f32 v39, v39, v179
    v_cvt_pk_bf16_f32 v201, v178, v179
    v_exp_f32 v182, v182
    v_exp_f32 v183, v183
    v_add_f32 v37, v37, v180
    v_add_f32 v39, v39, v181
    v_cvt_pk_bf16_f32 v202, v180, v181
    v_exp_f32 v184, v184
    v_exp_f32 v185, v185
    v_add_f32 v37, v37, v182
    v_add_f32 v39, v39, v183
    v_cvt_pk_bf16_f32 v203, v182, v183
    v_exp_f32 v186, v186
    v_exp_f32 v187, v187
    v_add_f32 v37, v37, v184
    v_add_f32 v39, v39, v185
    v_cvt_pk_bf16_f32 v204, v184, v185
    v_exp_f32 v188, v188
    v_exp_f32 v189, v189
    v_add_f32 v37, v37, v186
    v_add_f32 v39, v39, v187
    v_cvt_pk_bf16_f32 v205, v186, v187
    v_exp_f32 v190, v190
    v_exp_f32 v191, v191
    v_add_f32 v37, v37, v188
    v_add_f32 v39, v39, v189
    v_cvt_pk_bf16_f32 v206, v188, v189
    v_add_f32 v37, v37, v190
    v_add_f32 v39, v39, v191
    v_cvt_pk_bf16_f32 v207, v190, v191
    ds_read_b128 v[208:211], v10 offset:32768
    ds_read_b64_tr_b16 v[224:225], v26 offset:16384
    ds_read_b64_tr_b16 v[226:227], v26 offset:18432
    ds_read_b128 v[212:215], v11 offset:32768
    ds_read_b64_tr_b16 v[228:229], v27 offset:16384
    ds_read_b64_tr_b16 v[230:231], v27 offset:18432
    ds_read_b128 v[216:219], v12 offset:32768
    ds_read_b64_tr_b16 v[232:233], v28 offset:16384
    ds_read_b64_tr_b16 v[234:235], v28 offset:18432
    ds_read_b128 v[220:223], v13 offset:32768
    ds_read_b64_tr_b16 v[236:237], v29 offset:16384
    ds_read_b64_tr_b16 v[238:239], v29 offset:18432
    s_waitcnt vmcnt(4)
    s_barrier
    s_setprio 1
    s_waitcnt lgkmcnt(11)
    v_mfma_f32_32x32x16_bf16 v[160:175], v[208:211], v[48:51], v[144:159]
    ds_read_b128 v[208:211], v14 offset:32768
    s_waitcnt lgkmcnt(10)
    v_mfma_f32_32x32x16_bf16 v[80:95], v[224:227], v[192:195], v[80:95]
    ds_read_b64_tr_b16 v[224:225], v26 offset:20480
    ds_read_b64_tr_b16 v[226:227], v26 offset:22528
    s_waitcnt lgkmcnt(11)
    v_mfma_f32_32x32x16_bf16 v[160:175], v[212:215], v[52:55], v[160:175]
    ds_read_b128 v[212:215], v15 offset:32768
    s_waitcnt lgkmcnt(10)
    v_mfma_f32_32x32x16_bf16 v[96:111], v[228:231], v[192:195], v[96:111]
    ds_read_b64_tr_b16 v[228:229], v27 offset:20480
    ds_read_b64_tr_b16 v[230:231], v27 offset:22528
    s_waitcnt lgkmcnt(11)
    v_mfma_f32_32x32x16_bf16 v[160:175], v[216:219], v[56:59], v[160:175]
    ds_read_b128 v[216:219], v16 offset:32768
    s_waitcnt lgkmcnt(10)
    v_mfma_f32_32x32x16_bf16 v[112:127], v[232:235], v[192:195], v[112:127]
    ds_read_b64_tr_b16 v[232:233], v28 offset:20480
    ds_read_b64_tr_b16 v[234:235], v28 offset:22528
    s_waitcnt lgkmcnt(11)
    v_mfma_f32_32x32x16_bf16 v[160:175], v[220:223], v[60:63], v[160:175]
    ds_read_b128 v[220:223], v17 offset:32768
    s_waitcnt lgkmcnt(10)
    v_mfma_f32_32x32x16_bf16 v[128:143], v[236:239], v[192:195], v[128:143]
    ds_read_b64_tr_b16 v[236:237], v29 offset:20480
    ds_read_b64_tr_b16 v[238:239], v29 offset:22528
    s_waitcnt lgkmcnt(11)
    v_mfma_f32_32x32x16_bf16 v[160:175], v[208:211], v[64:67], v[160:175]
    ds_read_b128 v[208:211], v10 offset:40960
    s_waitcnt lgkmcnt(10)
    v_mfma_f32_32x32x16_bf16 v[80:95], v[224:227], v[196:199], v[80:95]
    ds_read_b64_tr_b16 v[224:225], v26 offset:24576
    ds_read_b64_tr_b16 v[226:227], v26 offset:26624
    s_waitcnt lgkmcnt(11)
    v_mfma_f32_32x32x16_bf16 v[160:175], v[212:215], v[68:71], v[160:175]
    ds_read_b128 v[212:215], v11 offset:40960
    s_waitcnt lgkmcnt(10)
    v_mfma_f32_32x32x16_bf16 v[96:111], v[228:231], v[196:199], v[96:111]
    ds_read_b64_tr_b16 v[228:229], v27 offset:24576
    ds_read_b64_tr_b16 v[230:231], v27 offset:26624
    s_waitcnt lgkmcnt(11)
    v_mfma_f32_32x32x16_bf16 v[160:175], v[216:219], v[72:75], v[160:175]
    ds_read_b128 v[216:219], v12 offset:40960
    s_waitcnt lgkmcnt(10)
    v_mfma_f32_32x32x16_bf16 v[112:127], v[232:235], v[196:199], v[112:127]
    ds_read_b64_tr_b16 v[232:233], v28 offset:24576
    ds_read_b64_tr_b16 v[234:235], v28 offset:26624
    s_waitcnt lgkmcnt(11)
    v_mfma_f32_32x32x16_bf16 v[160:175], v[220:223], v[76:79], v[160:175]
    ds_read_b128 v[220:223], v13 offset:40960
    s_waitcnt lgkmcnt(10)
    v_mfma_f32_32x32x16_bf16 v[128:143], v[236:239], v[196:199], v[128:143]
    ds_read_b64_tr_b16 v[236:237], v29 offset:24576
    ds_read_b64_tr_b16 v[238:239], v29 offset:26624
    s_waitcnt lgkmcnt(11)
    v_mfma_f32_32x32x16_bf16 v[176:191], v[208:211], v[48:51], v[144:159]
    ds_read_b128 v[208:211], v14 offset:40960
    s_waitcnt lgkmcnt(10)
    v_mfma_f32_32x32x16_bf16 v[80:95], v[224:227], v[200:203], v[80:95]
    ds_read_b64_tr_b16 v[224:225], v26 offset:28672
    ds_read_b64_tr_b16 v[226:227], v26 offset:30720
    s_waitcnt lgkmcnt(11)
    v_mfma_f32_32x32x16_bf16 v[176:191], v[212:215], v[52:55], v[176:191]
    ds_read_b128 v[212:215], v15 offset:40960
    s_waitcnt lgkmcnt(10)
    v_mfma_f32_32x32x16_bf16 v[96:111], v[228:231], v[200:203], v[96:111]
    ds_read_b64_tr_b16 v[228:229], v27 offset:28672
    ds_read_b64_tr_b16 v[230:231], v27 offset:30720
    s_waitcnt lgkmcnt(11)
    v_mfma_f32_32x32x16_bf16 v[176:191], v[216:219], v[56:59], v[176:191]
    ds_read_b128 v[216:219], v16 offset:40960
    s_waitcnt lgkmcnt(10)
    v_mfma_f32_32x32x16_bf16 v[112:127], v[232:235], v[200:203], v[112:127]
    ds_read_b64_tr_b16 v[232:233], v28 offset:28672
    ds_read_b64_tr_b16 v[234:235], v28 offset:30720
    s_waitcnt lgkmcnt(11)
    v_mfma_f32_32x32x16_bf16 v[176:191], v[220:223], v[60:63], v[176:191]
    ds_read_b128 v[220:223], v17 offset:40960
    s_waitcnt lgkmcnt(10)
    v_mfma_f32_32x32x16_bf16 v[128:143], v[236:239], v[200:203], v[128:143]
    ds_read_b64_tr_b16 v[236:237], v29 offset:28672
    ds_read_b64_tr_b16 v[238:239], v29 offset:30720
    s_waitcnt lgkmcnt(11)
    v_mfma_f32_32x32x16_bf16 v[176:191], v[208:211], v[64:67], v[176:191]
    s_waitcnt lgkmcnt(9)
    v_mfma_f32_32x32x16_bf16 v[80:95], v[224:227], v[204:207], v[80:95]
    s_waitcnt lgkmcnt(8)
    v_mfma_f32_32x32x16_bf16 v[176:191], v[212:215], v[68:71], v[176:191]
    s_waitcnt lgkmcnt(6)
    v_mfma_f32_32x32x16_bf16 v[96:111], v[228:231], v[204:207], v[96:111]
    s_waitcnt lgkmcnt(5)
    v_mfma_f32_32x32x16_bf16 v[176:191], v[216:219], v[72:75], v[176:191]
    s_waitcnt lgkmcnt(3)
    v_mfma_f32_32x32x16_bf16 v[112:127], v[232:235], v[204:207], v[112:127]
    s_waitcnt lgkmcnt(2)
    v_mfma_f32_32x32x16_bf16 v[176:191], v[220:223], v[76:79], v[176:191]
    s_waitcnt lgkmcnt(0)
    v_mfma_f32_32x32x16_bf16 v[128:143], v[236:239], v[204:207], v[128:143]
    s_setprio 0
    s_waitcnt vmcnt(4)
    s_barrier
    s_add_u32 m0, s25, 0
    s_nop 0
    buffer_load_dwordx4 v34, s[4:7], s26 offen lds
    s_add_u32 m0, s25, 1024
    s_nop 0
    buffer_load_dwordx4 v35, s[4:7], s26 offen lds
    s_add_u32 m0, s25, 114688
    s_nop 0
    buffer_load_dwordx4 v36, s[8:11], s42 offen lds
    buffer_load_dwordx4 v36, s[8:11], s42 offen offset:1024 lds
    s_add_u32 s26, s26, 16384
    s_add_u32 s42, s42, 16384
    v_max3_f32 v38, v160, v161, v162
    v_max3_f32 v38, v38, v163, v164
    v_max3_f32 v38, v38, v165, v166
    v_max3_f32 v38, v38, v167, v168
    v_max3_f32 v38, v38, v169, v170
    v_max3_f32 v38, v38, v171, v172
    v_max3_f32 v38, v38, v173, v174
    v_max3_f32 v38, v38, v175, v176
    v_max3_f32 v38, v38, v177, v178
    v_max3_f32 v38, v38, v179, v180
    v_max3_f32 v38, v38, v181, v182
    v_max3_f32 v38, v38, v183, v184
    v_max3_f32 v38, v38, v185, v186
    v_max3_f32 v38, v38, v187, v188
    v_max3_f32 v38, v38, v189, v190
    v_max_f32 v38, v38, v191
    v_cmp_lt_f32 vcc, s28, v38
    s_nop 4
    s_cbranch_vccz K1_nr_l1
    v_mov_b32 v6, v38
    v_mov_b32 v7, v38
    s_nop 0
    s_nop 0
    v_permlane32_swap_b32 v6, v7
    v_max_f32 v41, v6, v7
    v_max_f32 v41, s29, v41
    v_sub_f32 v42, 0, v41
    v_min_f32 v42, 0x42c80000, v42
    v_exp_f32 v42, v42
    v_sub_f32 v160, v160, v41
    v_sub_f32 v161, v161, v41
    v_sub_f32 v162, v162, v41
    v_sub_f32 v163, v163, v41
    v_sub_f32 v164, v164, v41
    v_sub_f32 v165, v165, v41
    v_sub_f32 v166, v166, v41
    v_sub_f32 v167, v167, v41
    v_sub_f32 v168, v168, v41
    v_sub_f32 v169, v169, v41
    v_sub_f32 v170, v170, v41
    v_sub_f32 v171, v171, v41
    v_sub_f32 v172, v172, v41
    v_sub_f32 v173, v173, v41
    v_sub_f32 v174, v174, v41
    v_sub_f32 v175, v175, v41
    v_sub_f32 v176, v176, v41
    v_sub_f32 v177, v177, v41
    v_sub_f32 v178, v178, v41
    v_sub_f32 v179, v179, v41
    v_sub_f32 v180, v180, v41
    v_sub_f32 v181, v181, v41
    v_sub_f32 v182, v182, v41
    v_sub_f32 v183, v183, v41
    v_sub_f32 v184, v184, v41
    v_sub_f32 v185, v185, v41
    v_sub_f32 v186, v186, v41
    v_sub_f32 v187, v187, v41
    v_sub_f32 v188, v188, v41
    v_sub_f32 v189, v189, v41
    v_sub_f32 v190, v190, v41
    v_sub_f32 v191, v191, v41
    v_sub_f32 v144, v144, v41
    v_sub_f32 v145, v145, v41
    v_sub_f32 v146, v146, v41
    v_sub_f32 v147, v147, v41
    v_sub_f32 v148, v148, v41
    v_sub_f32 v149, v149, v41
    v_sub_f32 v150, v150, v41
    v_sub_f32 v151, v151, v41
    v_sub_f32 v152, v152, v41
    v_sub_f32 v153, v153, v41
    v_sub_f32 v154, v154, v41
    v_sub_f32 v155, v155, v41
    v_sub_f32 v156, v156, v41
    v_sub_f32 v157, v157, v41
    v_sub_f32 v158, v158, v41
    v_sub_f32 v159, v159, v41
    v_mul_f32 v37, v37, v42
    v_mul_f32 v39, v39, v42
    v_mul_f32 v80, v80, v42
    v_mul_f32 v81, v81, v42
    v_mul_f32 v82, v82, v42
    v_mul_f32 v83, v83, v42
    v_mul_f32 v84, v84, v42
    v_mul_f32 v85, v85, v42
    v_mul_f32 v86, v86, v42
    v_mul_f32 v87, v87, v42
    v_mul_f32 v88, v88, v42
    v_mul_f32 v89, v89, v42
    v_mul_f32 v90, v90, v42
    v_mul_f32 v91, v91, v42
    v_mul_f32 v92, v92, v42
    v_mul_f32 v93, v93, v42
    v_mul_f32 v94, v94, v42
    v_mul_f32 v95, v95, v42
    v_mul_f32 v96, v96, v42
    v_mul_f32 v97, v97, v42
    v_mul_f32 v98, v98, v42
    v_mul_f32 v99, v99, v42
    v_mul_f32 v100, v100, v42
    v_mul_f32 v101, v101, v42
    v_mul_f32 v102, v102, v42
    v_mul_f32 v103, v103, v42
    v_mul_f32 v104, v104, v42
    v_mul_f32 v105, v105, v42
    v_mul_f32 v106, v106, v42
    v_mul_f32 v107, v107, v42
    v_mul_f32 v108, v108, v42
    v_mul_f32 v109, v109, v42
    v_mul_f32 v110, v110, v42
    v_mul_f32 v111, v111, v42
    v_mul_f32 v112, v112, v42
    v_mul_f32 v113, v113, v42
    v_mul_f32 v114, v114, v42
    v_mul_f32 v115, v115, v42
    v_mul_f32 v116, v116, v42
    v_mul_f32 v117, v117, v42
    v_mul_f32 v118, v118, v42
    v_mul_f32 v119, v119, v42
    v_mul_f32 v120, v120, v42
    v_mul_f32 v121, v121, v42
    v_mul_f32 v122, v122, v42
    v_mul_f32 v123, v123, v42
    v_mul_f32 v124, v124, v42
    v_mul_f32 v125, v125, v42
    v_mul_f32 v126, v126, v42
    v_mul_f32 v127, v127, v42
    v_mul_f32 v128, v128, v42
    v_mul_f32 v129, v129, v42
    v_mul_f32 v130, v130, v42
    v_mul_f32 v131, v131, v42
    v_mul_f32 v132, v132, v42
    v_mul_f32 v133, v133, v42
    v_mul_f32 v134, v134, v42
    v_mul_f32 v135, v135, v42
    v_mul_f32 v136, v136, v42
    v_mul_f32 v137, v137, v42
    v_mul_f32 v138, v138, v42
    v_mul_f32 v139, v139, v42
    v_mul_f32 v140, v140, v42
    v_mul_f32 v141, v141, v42
    v_mul_f32 v142, v142, v42
    v_mul_f32 v143, v143, v42
    s_nop 15
K1_nr_l1:
    s_mov_b32 s28, 0x41000000
    s_mov_b32 s29, 0
    v_exp_f32 v160, v160
    v_exp_f32 v161, v161
    v_exp_f32 v162, v162
    v_exp_f32 v163, v163
    v_add_f32 v37, v37, v160
    v_add_f32 v39, v39, v161
    v_cvt_pk_bf16_f32 v192, v160, v161
    v_exp_f32 v164, v164
    v_exp_f32 v165, v165
    v_add_f32 v37, v37, v162
    v_add_f32 v39, v39, v163
    v_cvt_pk_bf16_f32 v193, v162, v163
    v_exp_f32 v166, v166
    v_exp_f32 v167, v167
    v_add_f32 v37, v37, v164
    v_add_f32 v39, v39, v165
    v_cvt_pk_bf16_f32 v194, v164, v165
    v_exp_f32 v168, v168
    v_exp_f32 v169, v169
    v_add_f32 v37, v37, v166
    v_add_f32 v39, v39, v167
    v_cvt_pk_bf16_f32 v195, v166, v167
    v_exp_f32 v170, v170
    v_exp_f32 v171, v171
    v_add_f32 v37, v37, v168
    v_add_f32 v39, v39, v169
    v_cvt_pk_bf16_f32 v196, v168, v169
    v_exp_f32 v172, v172
    v_exp_f32 v173, v173
    v_add_f32 v37, v37, v170
    v_add_f32 v39, v39, v171
    v_cvt_pk_bf16_f32 v197, v170, v171
    v_exp_f32 v174, v174
    v_exp_f32 v175, v175
    v_add_f32 v37, v37, v172
    v_add_f32 v39, v39, v173
    v_cvt_pk_bf16_f32 v198, v172, v173
    v_exp_f32 v176, v176
    v_exp_f32 v177, v177
    v_add_f32 v37, v37, v174
    v_add_f32 v39, v39, v175
    v_cvt_pk_bf16_f32 v199, v174, v175
    v_exp_f32 v178, v178
    v_exp_f32 v179, v179
    v_add_f32 v37, v37, v176
    v_add_f32 v39, v39, v177
    v_cvt_pk_bf16_f32 v200, v176, v177
    v_exp_f32 v180, v180
    v_exp_f32 v181, v181
    v_add_f32 v37, v37, v178
    v_add_f32 v39, v39, v179
    v_cvt_pk_bf16_f32 v201, v178, v179
    v_exp_f32 v182, v182
    v_exp_f32 v183, v183
    v_add_f32 v37, v37, v180
    v_add_f32 v39, v39, v181
    v_cvt_pk_bf16_f32 v202, v180, v181
    v_exp_f32 v184, v184
    v_exp_f32 v185, v185
    v_add_f32 v37, v37, v182
    v_add_f32 v39, v39, v183
    v_cvt_pk_bf16_f32 v203, v182, v183
    v_exp_f32 v186, v186
    v_exp_f32 v187, v187
    v_add_f32 v37, v37, v184
    v_add_f32 v39, v39, v185
    v_cvt_pk_bf16_f32 v204, v184, v185
    v_exp_f32 v188, v188
    v_exp_f32 v189, v189
    v_add_f32 v37, v37, v186
    v_add_f32 v39, v39, v187
    v_cvt_pk_bf16_f32 v205, v186, v187
    v_exp_f32 v190, v190
    v_exp_f32 v191, v191
    v_add_f32 v37, v37, v188
    v_add_f32 v39, v39, v189
    v_cvt_pk_bf16_f32 v206, v188, v189
    v_add_f32 v37, v37, v190
    v_add_f32 v39, v39, v191
    v_cvt_pk_bf16_f32 v207, v190, v191
    ds_read_b128 v[208:211], v18 offset:0
    ds_read_b64_tr_b16 v[224:225], v26 offset:49152
    ds_read_b64_tr_b16 v[226:227], v26 offset:51200
    ds_read_b128 v[212:215], v19 offset:0
    ds_read_b64_tr_b16 v[228:229], v27 offset:49152
    ds_read_b64_tr_b16 v[230:231], v27 offset:51200
    ds_read_b128 v[216:219], v20 offset:0
    ds_read_b64_tr_b16 v[232:233], v28 offset:49152
    ds_read_b64_tr_b16 v[234:235], v28 offset:51200
    ds_read_b128 v[220:223], v21 offset:0
    ds_read_b64_tr_b16 v[236:237], v29 offset:49152
    ds_read_b64_tr_b16 v[238:239], v29 offset:51200
    s_waitcnt vmcnt(4)
    s_barrier
    s_setprio 1
    s_waitcnt lgkmcnt(11)
    v_mfma_f32_32x32x16_bf16 v[160:175], v[208:211], v[48:51], v[144:159]
    ds_read_b128 v[208:211], v22 offset:0
    s_waitcnt lgkmcnt(10)
    v_mfma_f32_32x32x16_bf16 v[80:95], v[224:227], v[192:195], v[80:95]
    ds_read_b64_tr_b16 v[224:225], v26 offset:53248
    ds_read_b64_tr_b16 v[226:227], v26 offset:55296
    s_waitcnt lgkmcnt(11)
    v_mfma_f32_32x32x16_bf16 v[160:175], v[212:215], v[52:55], v[160:175]
    ds_read_b128 v[212:215], v23 offset:0
    s_waitcnt lgkmcnt(10)
    v_mfma_f32_32x32x16_bf16 v[96:111], v[228:231], v[192:195], v[96:111]
    ds_read_b64_tr_b16 v[228:229], v27 offset:53248
    ds_read_b64_tr_b16 v[230:231], v27 offset:55296
    s_waitcnt lgkmcnt(11)
    v_mfma_f32_32x32x16_bf16 v[160:175], v[216:219], v[56:59], v[160:175]
    ds_read_b128 v[216:219], v24 offset:0
    s_waitcnt lgkmcnt(10)
    v_mfma_f32_32x32x16_bf16 v[112:127], v[232:235], v[192:195], v[112:127]
    ds_read_b64_tr_b16 v[232:233], v28 offset:53248
    ds_read_b64_tr_b16 v[234:235], v28 offset:55296
    s_waitcnt lgkmcnt(11)
    v_mfma_f32_32x32x16_bf16 v[160:175], v[220:223], v[60:63], v[160:175]
    ds_read_b128 v[220:223], v25 offset:0
    s_waitcnt lgkmcnt(10)
    v_mfma_f32_32x32x16_bf16 v[128:143], v[236:239], v[192:195], v[128:143]
    ds_read_b64_tr_b16 v[236:237], v29 offset:53248
    ds_read_b64_tr_b16 v[238:239], v29 offset:55296
    s_waitcnt lgkmcnt(11)
    v_mfma_f32_32x32x16_bf16 v[160:175], v[208:211], v[64:67], v[160:175]
    ds_read_b128 v[208:211], v18 offset:8192
    s_waitcnt lgkmcnt(10)
    v_mfma_f32_32x32x16_bf16 v[80:95], v[224:227], v[196:199], v[80:95]
    ds_read_b64_tr_b16 v[224:225], v26 offset:57344
    ds_read_b64_tr_b16 v[226:227], v26 offset:59392
    s_waitcnt lgkmcnt(11)
    v_mfma_f32_32x32x16_bf16 v[160:175], v[212:215], v[68:71], v[160:175]
    ds_read_b128 v[212:215], v19 offset:8192
    s_waitcnt lgkmcnt(10)
    v_mfma_f32_32x32x16_bf16 v[96:111], v[228:231], v[196:199], v[96:111]
    ds_read_b64_tr_b16 v[228:229], v27 offset:57344
    ds_read_b64_tr_b16 v[230:231], v27 offset:59392
    s_waitcnt lgkmcnt(11)
    v_mfma_f32_32x32x16_bf16 v[160:175], v[216:219], v[72:75], v[160:175]
    ds_read_b128 v[216:219], v20 offset:8192
    s_waitcnt lgkmcnt(10)
    v_mfma_f32_32x32x16_bf16 v[112:127], v[232:235], v[196:199], v[112:127]
    ds_read_b64_tr_b16 v[232:233], v28 offset:57344
    ds_read_b64_tr_b16 v[234:235], v28 offset:59392
    s_waitcnt lgkmcnt(11)
    v_mfma_f32_32x32x16_bf16 v[160:175], v[220:223], v[76:79], v[160:175]
    ds_read_b128 v[220:223], v21 offset:8192
    s_waitcnt lgkmcnt(10)
    v_mfma_f32_32x32x16_bf16 v[128:143], v[236:239], v[196:199], v[128:143]
    ds_read_b64_tr_b16 v[236:237], v29 offset:57344
    ds_read_b64_tr_b16 v[238:239], v29 offset:59392
    s_waitcnt lgkmcnt(11)
    v_mfma_f32_32x32x16_bf16 v[176:191], v[208:211], v[48:51], v[144:159]
    ds_read_b128 v[208:211], v22 offset:8192
    s_waitcnt lgkmcnt(10)
    v_mfma_f32_32x32x16_bf16 v[80:95], v[224:227], v[200:203], v[80:95]
    ds_read_b64_tr_b16 v[224:225], v26 offset:61440
    ds_read_b64_tr_b16 v[226:227], v26 offset:63488
    s_waitcnt lgkmcnt(11)
    v_mfma_f32_32x32x16_bf16 v[176:191], v[212:215], v[52:55], v[176:191]
    ds_read_b128 v[212:215], v23 offset:8192
    s_waitcnt lgkmcnt(10)
    v_mfma_f32_32x32x16_bf16 v[96:111], v[228:231], v[200:203], v[96:111]
    ds_read_b64_tr_b16 v[228:229], v27 offset:61440
    ds_read_b64_tr_b16 v[230:231], v27 offset:63488
    s_waitcnt lgkmcnt(11)
    v_mfma_f32_32x32x16_bf16 v[176:191], v[216:219], v[56:59], v[176:191]
    ds_read_b128 v[216:219], v24 offset:8192
    s_waitcnt lgkmcnt(10)
    v_mfma_f32_32x32x16_bf16 v[112:127], v[232:235], v[200:203], v[112:127]
    ds_read_b64_tr_b16 v[232:233], v28 offset:61440
    ds_read_b64_tr_b16 v[234:235], v28 offset:63488
    s_waitcnt lgkmcnt(11)
    v_mfma_f32_32x32x16_bf16 v[176:191], v[220:223], v[60:63], v[176:191]
    ds_read_b128 v[220:223], v25 offset:8192
    s_waitcnt lgkmcnt(10)
    v_mfma_f32_32x32x16_bf16 v[128:143], v[236:239], v[200:203], v[128:143]
    ds_read_b64_tr_b16 v[236:237], v29 offset:61440
    ds_read_b64_tr_b16 v[238:239], v29 offset:63488
    s_waitcnt lgkmcnt(11)
    v_mfma_f32_32x32x16_bf16 v[176:191], v[208:211], v[64:67], v[176:191]
    s_waitcnt lgkmcnt(9)
    v_mfma_f32_32x32x16_bf16 v[80:95], v[224:227], v[204:207], v[80:95]
    s_waitcnt lgkmcnt(8)
    v_mfma_f32_32x32x16_bf16 v[176:191], v[212:215], v[68:71], v[176:191]
    s_waitcnt lgkmcnt(6)
    v_mfma_f32_32x32x16_bf16 v[96:111], v[228:231], v[204:207], v[96:111]
    s_waitcnt lgkmcnt(5)
    v_mfma_f32_32x32x16_bf16 v[176:191], v[216:219], v[72:75], v[176:191]
    s_waitcnt lgkmcnt(3)
    v_mfma_f32_32x32x16_bf16 v[112:127], v[232:235], v[204:207], v[112:127]
    s_waitcnt lgkmcnt(2)
    v_mfma_f32_32x32x16_bf16 v[176:191], v[220:223], v[76:79], v[176:191]
    s_waitcnt lgkmcnt(0)
    v_mfma_f32_32x32x16_bf16 v[128:143], v[236:239], v[204:207], v[128:143]
    s_setprio 0
    s_waitcnt vmcnt(4)
    s_barrier
    s_add_u32 m0, s25, 32768
    s_nop 0
    buffer_load_dwordx4 v34, s[4:7], s26 offen lds
    s_add_u32 m0, s25, 33792
    s_nop 0
    buffer_load_dwordx4 v35, s[4:7], s26 offen lds
    s_add_u32 m0, s25, 16384
    s_nop 0
    buffer_load_dwordx4 v36, s[8:11], s42 offen lds
    buffer_load_dwordx4 v36, s[8:11], s42 offen offset:1024 lds
    s_add_u32 s26, s26, 16384
    s_add_u32 s42, s42, 16384
    v_max3_f32 v38, v160, v161, v162
    v_max3_f32 v38, v38, v163, v164
    v_max3_f32 v38, v38, v165, v166
    v_max3_f32 v38, v38, v167, v168
    v_max3_f32 v38, v38, v169, v170
    v_max3_f32 v38, v38, v171, v172
    v_max3_f32 v38, v38, v173, v174
    v_max3_f32 v38, v38, v175, v176
    v_max3_f32 v38, v38, v177, v178
    v_max3_f32 v38, v38, v179, v180
    v_max3_f32 v38, v38, v181, v182
    v_max3_f32 v38, v38, v183, v184
    v_max3_f32 v38, v38, v185, v186
    v_max3_f32 v38, v38, v187, v188
    v_max3_f32 v38, v38, v189, v190
    v_max_f32 v38, v38, v191
    v_cmp_lt_f32 vcc, s28, v38
    s_nop 4
    s_cbranch_vccz K1_nr_l2
    v_mov_b32 v6, v38
    v_mov_b32 v7, v38
    s_nop 0
    s_nop 0
    v_permlane32_swap_b32 v6, v7
    v_max_f32 v41, v6, v7
    v_max_f32 v41, s29, v41
    v_sub_f32 v42, 0, v41
    v_min_f32 v42, 0x42c80000, v42
    v_exp_f32 v42, v42
    v_sub_f32 v160, v160, v41
    v_sub_f32 v161, v161, v41
    v_sub_f32 v162, v162, v41
    v_sub_f32 v163, v163, v41
    v_sub_f32 v164, v164, v41
    v_sub_f32 v165, v165, v41
    v_sub_f32 v166, v166, v41
    v_sub_f32 v167, v167, v41
    v_sub_f32 v168, v168, v41
    v_sub_f32 v169, v169, v41
    v_sub_f32 v170, v170, v41
    v_sub_f32 v171, v171, v41
    v_sub_f32 v172, v172, v41
    v_sub_f32 v173, v173, v41
    v_sub_f32 v174, v174, v41
    v_sub_f32 v175, v175, v41
    v_sub_f32 v176, v176, v41
    v_sub_f32 v177, v177, v41
    v_sub_f32 v178, v178, v41
    v_sub_f32 v179, v179, v41
    v_sub_f32 v180, v180, v41
    v_sub_f32 v181, v181, v41
    v_sub_f32 v182, v182, v41
    v_sub_f32 v183, v183, v41
    v_sub_f32 v184, v184, v41
    v_sub_f32 v185, v185, v41
    v_sub_f32 v186, v186, v41
    v_sub_f32 v187, v187, v41
    v_sub_f32 v188, v188, v41
    v_sub_f32 v189, v189, v41
    v_sub_f32 v190, v190, v41
    v_sub_f32 v191, v191, v41
    v_sub_f32 v144, v144, v41
    v_sub_f32 v145, v145, v41
    v_sub_f32 v146, v146, v41
    v_sub_f32 v147, v147, v41
    v_sub_f32 v148, v148, v41
    v_sub_f32 v149, v149, v41
    v_sub_f32 v150, v150, v41
    v_sub_f32 v151, v151, v41
    v_sub_f32 v152, v152, v41
    v_sub_f32 v153, v153, v41
    v_sub_f32 v154, v154, v41
    v_sub_f32 v155, v155, v41
    v_sub_f32 v156, v156, v41
    v_sub_f32 v157, v157, v41
    v_sub_f32 v158, v158, v41
    v_sub_f32 v159, v159, v41
    v_mul_f32 v37, v37, v42
    v_mul_f32 v39, v39, v42
    v_mul_f32 v80, v80, v42
    v_mul_f32 v81, v81, v42
    v_mul_f32 v82, v82, v42
    v_mul_f32 v83, v83, v42
    v_mul_f32 v84, v84, v42
    v_mul_f32 v85, v85, v42
    v_mul_f32 v86, v86, v42
    v_mul_f32 v87, v87, v42
    v_mul_f32 v88, v88, v42
    v_mul_f32 v89, v89, v42
    v_mul_f32 v90, v90, v42
    v_mul_f32 v91, v91, v42
    v_mul_f32 v92, v92, v42
    v_mul_f32 v93, v93, v42
    v_mul_f32 v94, v94, v42
    v_mul_f32 v95, v95, v42
    v_mul_f32 v96, v96, v42
    v_mul_f32 v97, v97, v42
    v_mul_f32 v98, v98, v42
    v_mul_f32 v99, v99, v42
    v_mul_f32 v100, v100, v42
    v_mul_f32 v101, v101, v42
    v_mul_f32 v102, v102, v42
    v_mul_f32 v103, v103, v42
    v_mul_f32 v104, v104, v42
    v_mul_f32 v105, v105, v42
    v_mul_f32 v106, v106, v42
    v_mul_f32 v107, v107, v42
    v_mul_f32 v108, v108, v42
    v_mul_f32 v109, v109, v42
    v_mul_f32 v110, v110, v42
    v_mul_f32 v111, v111, v42
    v_mul_f32 v112, v112, v42
    v_mul_f32 v113, v113, v42
    v_mul_f32 v114, v114, v42
    v_mul_f32 v115, v115, v42
    v_mul_f32 v116, v116, v42
    v_mul_f32 v117, v117, v42
    v_mul_f32 v118, v118, v42
    v_mul_f32 v119, v119, v42
    v_mul_f32 v120, v120, v42
    v_mul_f32 v121, v121, v42
    v_mul_f32 v122, v122, v42
    v_mul_f32 v123, v123, v42
    v_mul_f32 v124, v124, v42
    v_mul_f32 v125, v125, v42
    v_mul_f32 v126, v126, v42
    v_mul_f32 v127, v127, v42
    v_mul_f32 v128, v128, v42
    v_mul_f32 v129, v129, v42
    v_mul_f32 v130, v130, v42
    v_mul_f32 v131, v131, v42
    v_mul_f32 v132, v132, v42
    v_mul_f32 v133, v133, v42
    v_mul_f32 v134, v134, v42
    v_mul_f32 v135, v135, v42
    v_mul_f32 v136, v136, v42
    v_mul_f32 v137, v137, v42
    v_mul_f32 v138, v138, v42
    v_mul_f32 v139, v139, v42
    v_mul_f32 v140, v140, v42
    v_mul_f32 v141, v141, v42
    v_mul_f32 v142, v142, v42
    v_mul_f32 v143, v143, v42
    s_nop 15
K1_nr_l2:
    s_mov_b32 s28, 0x41000000
    s_mov_b32 s29, 0
    v_exp_f32 v160, v160
    v_exp_f32 v161, v161
    v_exp_f32 v162, v162
    v_exp_f32 v163, v163
    v_add_f32 v37, v37, v160
    v_add_f32 v39, v39, v161
    v_cvt_pk_bf16_f32 v192, v160, v161
    v_exp_f32 v164, v164
    v_exp_f32 v165, v165
    v_add_f32 v37, v37, v162
    v_add_f32 v39, v39, v163
    v_cvt_pk_bf16_f32 v193, v162, v163
    v_exp_f32 v166, v166
    v_exp_f32 v167, v167
    v_add_f32 v37, v37, v164
    v_add_f32 v39, v39, v165
    v_cvt_pk_bf16_f32 v194, v164, v165
    v_exp_f32 v168, v168
    v_exp_f32 v169, v169
    v_add_f32 v37, v37, v166
    v_add_f32 v39, v39, v167
    v_cvt_pk_bf16_f32 v195, v166, v167
    v_exp_f32 v170, v170
    v_exp_f32 v171, v171
    v_add_f32 v37, v37, v168
    v_add_f32 v39, v39, v169
    v_cvt_pk_bf16_f32 v196, v168, v169
    v_exp_f32 v172, v172
    v_exp_f32 v173, v173
    v_add_f32 v37, v37, v170
    v_add_f32 v39, v39, v171
    v_cvt_pk_bf16_f32 v197, v170, v171
    v_exp_f32 v174, v174
    v_exp_f32 v175, v175
    v_add_f32 v37, v37, v172
    v_add_f32 v39, v39, v173
    v_cvt_pk_bf16_f32 v198, v172, v173
    v_exp_f32 v176, v176
    v_exp_f32 v177, v177
    v_add_f32 v37, v37, v174
    v_add_f32 v39, v39, v175
    v_cvt_pk_bf16_f32 v199, v174, v175
    v_exp_f32 v178, v178
    v_exp_f32 v179, v179
    v_add_f32 v37, v37, v176
    v_add_f32 v39, v39, v177
    v_cvt_pk_bf16_f32 v200, v176, v177
    v_exp_f32 v180, v180
    v_exp_f32 v181, v181
    v_add_f32 v37, v37, v178
    v_add_f32 v39, v39, v179
    v_cvt_pk_bf16_f32 v201, v178, v179
    v_exp_f32 v182, v182
    v_exp_f32 v183, v183
    v_add_f32 v37, v37, v180
    v_add_f32 v39, v39, v181
    v_cvt_pk_bf16_f32 v202, v180, v181
    v_exp_f32 v184, v184
    v_exp_f32 v185, v185
    v_add_f32 v37, v37, v182
    v_add_f32 v39, v39, v183
    v_cvt_pk_bf16_f32 v203, v182, v183
    v_exp_f32 v186, v186
    v_exp_f32 v187, v187
    v_add_f32 v37, v37, v184
    v_add_f32 v39, v39, v185
    v_cvt_pk_bf16_f32 v204, v184, v185
    v_exp_f32 v188, v188
    v_exp_f32 v189, v189
    v_add_f32 v37, v37, v186
    v_add_f32 v39, v39, v187
    v_cvt_pk_bf16_f32 v205, v186, v187
    v_exp_f32 v190, v190
    v_exp_f32 v191, v191
    v_add_f32 v37, v37, v188
    v_add_f32 v39, v39, v189
    v_cvt_pk_bf16_f32 v206, v188, v189
    v_add_f32 v37, v37, v190
    v_add_f32 v39, v39, v191
    v_cvt_pk_bf16_f32 v207, v190, v191
    ds_read_b128 v[208:211], v18 offset:32768
    ds_read_b64_tr_b16 v[224:225], v30 offset:16384
    ds_read_b64_tr_b16 v[226:227], v30 offset:18432
    ds_read_b128 v[212:215], v19 offset:32768
    ds_read_b64_tr_b16 v[228:229], v31 offset:16384
    ds_read_b64_tr_b16 v[230:231], v31 offset:18432
    ds_read_b128 v[216:219], v20 offset:32768
    ds_read_b64_tr_b16 v[232:233], v32 offset:16384
    ds_read_b64_tr_b16 v[234:235], v32 offset:18432
    ds_read_b128 v[220:223], v21 offset:32768
    ds_read_b64_tr_b16 v[236:237], v33 offset:16384
    ds_read_b64_tr_b16 v[238:239], v33 offset:18432
    s_waitcnt vmcnt(4)
    s_barrier
    s_setprio 1
    s_waitcnt lgkmcnt(11)
    v_mfma_f32_32x32x16_bf16 v[160:175], v[208:211], v[48:51], v[144:159]
    ds_read_b128 v[208:211], v22 offset:32768
    s_waitcnt lgkmcnt(10)
    v_mfma_f32_32x32x16_bf16 v[80:95], v[224:227], v[192:195], v[80:95]
    ds_read_b64_tr_b16 v[224:225], v30 offset:20480
    ds_read_b64_tr_b16 v[226:227], v30 offset:22528
    s_waitcnt lgkmcnt(11)
    v_mfma_f32_32x32x16_bf16 v[160:175], v[212:215], v[52:55], v[160:175]
    ds_read_b128 v[212:215], v23 offset:32768
    s_waitcnt lgkmcnt(10)
    v_mfma_f32_32x32x16_bf16 v[96:111], v[228:231], v[192:195], v[96:111]
    ds_read_b64_tr_b16 v[228:229], v31 offset:20480
    ds_read_b64_tr_b16 v[230:231], v31 offset:22528
    s_waitcnt lgkmcnt(11)
    v_mfma_f32_32x32x16_bf16 v[160:175], v[216:219], v[56:59], v[160:175]
    ds_read_b128 v[216:219], v24 offset:32768
    s_waitcnt lgkmcnt(10)
    v_mfma_f32_32x32x16_bf16 v[112:127], v[232:235], v[192:195], v[112:127]
    ds_read_b64_tr_b16 v[232:233], v32 offset:20480
    ds_read_b64_tr_b16 v[234:235], v32 offset:22528
    s_waitcnt lgkmcnt(11)
    v_mfma_f32_32x32x16_bf16 v[160:175], v[220:223], v[60:63], v[160:175]
    ds_read_b128 v[220:223], v25 offset:32768
    s_waitcnt lgkmcnt(10)
    v_mfma_f32_32x32x16_bf16 v[128:143], v[236:239], v[192:195], v[128:143]
    ds_read_b64_tr_b16 v[236:237], v33 offset:20480
    ds_read_b64_tr_b16 v[238:239], v33 offset:22528
    s_waitcnt lgkmcnt(11)
    v_mfma_f32_32x32x16_bf16 v[160:175], v[208:211], v[64:67], v[160:175]
    ds_read_b128 v[208:211], v18 offset:40960
    s_waitcnt lgkmcnt(10)
    v_mfma_f32_32x32x16_bf16 v[80:95], v[224:227], v[196:199], v[80:95]
    ds_read_b64_tr_b16 v[224:225], v30 offset:24576
    ds_read_b64_tr_b16 v[226:227], v30 offset:26624
    s_waitcnt lgkmcnt(11)
    v_mfma_f32_32x32x16_bf16 v[160:175], v[212:215], v[68:71], v[160:175]
    ds_read_b128 v[212:215], v19 offset:40960
    s_waitcnt lgkmcnt(10)
    v_mfma_f32_32x32x16_bf16 v[96:111], v[228:231], v[196:199], v[96:111]
    ds_read_b64_tr_b16 v[228:229], v31 offset:24576
    ds_read_b64_tr_b16 v[230:231], v31 offset:26624
    s_waitcnt lgkmcnt(11)
    v_mfma_f32_32x32x16_bf16 v[160:175], v[216:219], v[72:75], v[160:175]
    ds_read_b128 v[216:219], v20 offset:40960
    s_waitcnt lgkmcnt(10)
    v_mfma_f32_32x32x16_bf16 v[112:127], v[232:235], v[196:199], v[112:127]
    ds_read_b64_tr_b16 v[232:233], v32 offset:24576
    ds_read_b64_tr_b16 v[234:235], v32 offset:26624
    s_waitcnt lgkmcnt(11)
    v_mfma_f32_32x32x16_bf16 v[160:175], v[220:223], v[76:79], v[160:175]
    ds_read_b128 v[220:223], v21 offset:40960
    s_waitcnt lgkmcnt(10)
    v_mfma_f32_32x32x16_bf16 v[128:143], v[236:239], v[196:199], v[128:143]
    ds_read_b64_tr_b16 v[236:237], v33 offset:24576
    ds_read_b64_tr_b16 v[238:239], v33 offset:26624
    s_waitcnt lgkmcnt(11)
    v_mfma_f32_32x32x16_bf16 v[176:191], v[208:211], v[48:51], v[144:159]
    ds_read_b128 v[208:211], v22 offset:40960
    s_waitcnt lgkmcnt(10)
    v_mfma_f32_32x32x16_bf16 v[80:95], v[224:227], v[200:203], v[80:95]
    ds_read_b64_tr_b16 v[224:225], v30 offset:28672
    ds_read_b64_tr_b16 v[226:227], v30 offset:30720
    s_waitcnt lgkmcnt(11)
    v_mfma_f32_32x32x16_bf16 v[176:191], v[212:215], v[52:55], v[176:191]
    ds_read_b128 v[212:215], v23 offset:40960
    s_waitcnt lgkmcnt(10)
    v_mfma_f32_32x32x16_bf16 v[96:111], v[228:231], v[200:203], v[96:111]
    ds_read_b64_tr_b16 v[228:229], v31 offset:28672
    ds_read_b64_tr_b16 v[230:231], v31 offset:30720
    s_waitcnt lgkmcnt(11)
    v_mfma_f32_32x32x16_bf16 v[176:191], v[216:219], v[56:59], v[176:191]
    ds_read_b128 v[216:219], v24 offset:40960
    s_waitcnt lgkmcnt(10)
    v_mfma_f32_32x32x16_bf16 v[112:127], v[232:235], v[200:203], v[112:127]
    ds_read_b64_tr_b16 v[232:233], v32 offset:28672
    ds_read_b64_tr_b16 v[234:235], v32 offset:30720
    s_waitcnt lgkmcnt(11)
    v_mfma_f32_32x32x16_bf16 v[176:191], v[220:223], v[60:63], v[176:191]
    ds_read_b128 v[220:223], v25 offset:40960
    s_waitcnt lgkmcnt(10)
    v_mfma_f32_32x32x16_bf16 v[128:143], v[236:239], v[200:203], v[128:143]
    ds_read_b64_tr_b16 v[236:237], v33 offset:28672
    ds_read_b64_tr_b16 v[238:239], v33 offset:30720
    s_waitcnt lgkmcnt(11)
    v_mfma_f32_32x32x16_bf16 v[176:191], v[208:211], v[64:67], v[176:191]
    s_waitcnt lgkmcnt(9)
    v_mfma_f32_32x32x16_bf16 v[80:95], v[224:227], v[204:207], v[80:95]
    s_waitcnt lgkmcnt(8)
    v_mfma_f32_32x32x16_bf16 v[176:191], v[212:215], v[68:71], v[176:191]
    s_waitcnt lgkmcnt(6)
    v_mfma_f32_32x32x16_bf16 v[96:111], v[228:231], v[204:207], v[96:111]
    s_waitcnt lgkmcnt(5)
    v_mfma_f32_32x32x16_bf16 v[176:191], v[216:219], v[72:75], v[176:191]
    s_waitcnt lgkmcnt(3)
    v_mfma_f32_32x32x16_bf16 v[112:127], v[232:235], v[204:207], v[112:127]
    s_waitcnt lgkmcnt(2)
    v_mfma_f32_32x32x16_bf16 v[176:191], v[220:223], v[76:79], v[176:191]
    s_waitcnt lgkmcnt(0)
    v_mfma_f32_32x32x16_bf16 v[128:143], v[236:239], v[204:207], v[128:143]
    s_setprio 0
    s_waitcnt vmcnt(4)
    s_barrier
    s_add_u32 m0, s25, 65536
    s_nop 0
    buffer_load_dwordx4 v34, s[4:7], s26 offen lds
    s_add_u32 m0, s25, 66560
    s_nop 0
    buffer_load_dwordx4 v35, s[4:7], s26 offen lds
    s_add_u32 m0, s25, 49152
    s_nop 0
    buffer_load_dwordx4 v36, s[8:11], s42 offen lds
    buffer_load_dwordx4 v36, s[8:11], s42 offen offset:1024 lds
    s_add_u32 s26, s26, 16384
    s_add_u32 s42, s42, 16384
    v_max3_f32 v38, v160, v161, v162
    v_max3_f32 v38, v38, v163, v164
    v_max3_f32 v38, v38, v165, v166
    v_max3_f32 v38, v38, v167, v168
    v_max3_f32 v38, v38, v169, v170
    v_max3_f32 v38, v38, v171, v172
    v_max3_f32 v38, v38, v173, v174
    v_max3_f32 v38, v38, v175, v176
    v_max3_f32 v38, v38, v177, v178
    v_max3_f32 v38, v38, v179, v180
    v_max3_f32 v38, v38, v181, v182
    v_max3_f32 v38, v38, v183, v184
    v_max3_f32 v38, v38, v185, v186
    v_max3_f32 v38, v38, v187, v188
    v_max3_f32 v38, v38, v189, v190
    v_max_f32 v38, v38, v191
    v_cmp_lt_f32 vcc, s28, v38
    s_nop 4
    s_cbranch_vccz K1_nr_l3
    v_mov_b32 v6, v38
    v_mov_b32 v7, v38
    s_nop 0
    s_nop 0
    v_permlane32_swap_b32 v6, v7
    v_max_f32 v41, v6, v7
    v_max_f32 v41, s29, v41
    v_sub_f32 v42, 0, v41
    v_min_f32 v42, 0x42c80000, v42
    v_exp_f32 v42, v42
    v_sub_f32 v160, v160, v41
    v_sub_f32 v161, v161, v41
    v_sub_f32 v162, v162, v41
    v_sub_f32 v163, v163, v41
    v_sub_f32 v164, v164, v41
    v_sub_f32 v165, v165, v41
    v_sub_f32 v166, v166, v41
    v_sub_f32 v167, v167, v41
    v_sub_f32 v168, v168, v41
    v_sub_f32 v169, v169, v41
    v_sub_f32 v170, v170, v41
    v_sub_f32 v171, v171, v41
    v_sub_f32 v172, v172, v41
    v_sub_f32 v173, v173, v41
    v_sub_f32 v174, v174, v41
    v_sub_f32 v175, v175, v41
    v_sub_f32 v176, v176, v41
    v_sub_f32 v177, v177, v41
    v_sub_f32 v178, v178, v41
    v_sub_f32 v179, v179, v41
    v_sub_f32 v180, v180, v41
    v_sub_f32 v181, v181, v41
    v_sub_f32 v182, v182, v41
    v_sub_f32 v183, v183, v41
    v_sub_f32 v184, v184, v41
    v_sub_f32 v185, v185, v41
    v_sub_f32 v186, v186, v41
    v_sub_f32 v187, v187, v41
    v_sub_f32 v188, v188, v41
    v_sub_f32 v189, v189, v41
    v_sub_f32 v190, v190, v41
    v_sub_f32 v191, v191, v41
    v_sub_f32 v144, v144, v41
    v_sub_f32 v145, v145, v41
    v_sub_f32 v146, v146, v41
    v_sub_f32 v147, v147, v41
    v_sub_f32 v148, v148, v41
    v_sub_f32 v149, v149, v41
    v_sub_f32 v150, v150, v41
    v_sub_f32 v151, v151, v41
    v_sub_f32 v152, v152, v41
    v_sub_f32 v153, v153, v41
    v_sub_f32 v154, v154, v41
    v_sub_f32 v155, v155, v41
    v_sub_f32 v156, v156, v41
    v_sub_f32 v157, v157, v41
    v_sub_f32 v158, v158, v41
    v_sub_f32 v159, v159, v41
    v_mul_f32 v37, v37, v42
    v_mul_f32 v39, v39, v42
    v_mul_f32 v80, v80, v42
    v_mul_f32 v81, v81, v42
    v_mul_f32 v82, v82, v42
    v_mul_f32 v83, v83, v42
    v_mul_f32 v84, v84, v42
    v_mul_f32 v85, v85, v42
    v_mul_f32 v86, v86, v42
    v_mul_f32 v87, v87, v42
    v_mul_f32 v88, v88, v42
    v_mul_f32 v89, v89, v42
    v_mul_f32 v90, v90, v42
    v_mul_f32 v91, v91, v42
    v_mul_f32 v92, v92, v42
    v_mul_f32 v93, v93, v42
    v_mul_f32 v94, v94, v42
    v_mul_f32 v95, v95, v42
    v_mul_f32 v96, v96, v42
    v_mul_f32 v97, v97, v42
    v_mul_f32 v98, v98, v42
    v_mul_f32 v99, v99, v42
    v_mul_f32 v100, v100, v42
    v_mul_f32 v101, v101, v42
    v_mul_f32 v102, v102, v42
    v_mul_f32 v103, v103, v42
    v_mul_f32 v104, v104, v42
    v_mul_f32 v105, v105, v42
    v_mul_f32 v106, v106, v42
    v_mul_f32 v107, v107, v42
    v_mul_f32 v108, v108, v42
    v_mul_f32 v109, v109, v42
    v_mul_f32 v110, v110, v42
    v_mul_f32 v111, v111, v42
    v_mul_f32 v112, v112, v42
    v_mul_f32 v113, v113, v42
    v_mul_f32 v114, v114, v42
    v_mul_f32 v115, v115, v42
    v_mul_f32 v116, v116, v42
    v_mul_f32 v117, v117, v42
    v_mul_f32 v118, v118, v42
    v_mul_f32 v119, v119, v42
    v_mul_f32 v120, v120, v42
    v_mul_f32 v121, v121, v42
    v_mul_f32 v122, v122, v42
    v_mul_f32 v123, v123, v42
    v_mul_f32 v124, v124, v42
    v_mul_f32 v125, v125, v42
    v_mul_f32 v126, v126, v42
    v_mul_f32 v127, v127, v42
    v_mul_f32 v128, v128, v42
    v_mul_f32 v129, v129, v42
    v_mul_f32 v130, v130, v42
    v_mul_f32 v131, v131, v42
    v_mul_f32 v132, v132, v42
    v_mul_f32 v133, v133, v42
    v_mul_f32 v134, v134, v42
    v_mul_f32 v135, v135, v42
    v_mul_f32 v136, v136, v42
    v_mul_f32 v137, v137, v42
    v_mul_f32 v138, v138, v42
    v_mul_f32 v139, v139, v42
    v_mul_f32 v140, v140, v42
    v_mul_f32 v141, v141, v42
    v_mul_f32 v142, v142, v42
    v_mul_f32 v143, v143, v42
    s_nop 15
K1_nr_l3:
    s_mov_b32 s28, 0x41000000
    s_mov_b32 s29, 0
    v_exp_f32 v160, v160
    v_exp_f32 v161, v161
    v_exp_f32 v162, v162
    v_exp_f32 v163, v163
    v_add_f32 v37, v37, v160
    v_add_f32 v39, v39, v161
    v_cvt_pk_bf16_f32 v192, v160, v161
    v_exp_f32 v164, v164
    v_exp_f32 v165, v165
    v_add_f32 v37, v37, v162
    v_add_f32 v39, v39, v163
    v_cvt_pk_bf16_f32 v193, v162, v163
    v_exp_f32 v166, v166
    v_exp_f32 v167, v167
    v_add_f32 v37, v37, v164
    v_add_f32 v39, v39, v165
    v_cvt_pk_bf16_f32 v194, v164, v165
    v_exp_f32 v168, v168
    v_exp_f32 v169, v169
    v_add_f32 v37, v37, v166
    v_add_f32 v39, v39, v167
    v_cvt_pk_bf16_f32 v195, v166, v167
    v_exp_f32 v170, v170
    v_exp_f32 v171, v171
    v_add_f32 v37, v37, v168
    v_add_f32 v39, v39, v169
    v_cvt_pk_bf16_f32 v196, v168, v169
    v_exp_f32 v172, v172
    v_exp_f32 v173, v173
    v_add_f32 v37, v37, v170
    v_add_f32 v39, v39, v171
    v_cvt_pk_bf16_f32 v197, v170, v171
    v_exp_f32 v174, v174
    v_exp_f32 v175, v175
    v_add_f32 v37, v37, v172
    v_add_f32 v39, v39, v173
    v_cvt_pk_bf16_f32 v198, v172, v173
    v_exp_f32 v176, v176
    v_exp_f32 v177, v177
    v_add_f32 v37, v37, v174
    v_add_f32 v39, v39, v175
    v_cvt_pk_bf16_f32 v199, v174, v175
    v_exp_f32 v178, v178
    v_exp_f32 v179, v179
    v_add_f32 v37, v37, v176
    v_add_f32 v39, v39, v177
    v_cvt_pk_bf16_f32 v200, v176, v177
    v_exp_f32 v180, v180
    v_exp_f32 v181, v181
    v_add_f32 v37, v37, v178
    v_add_f32 v39, v39, v179
    v_cvt_pk_bf16_f32 v201, v178, v179
    v_exp_f32 v182, v182
    v_exp_f32 v183, v183
    v_add_f32 v37, v37, v180
    v_add_f32 v39, v39, v181
    v_cvt_pk_bf16_f32 v202, v180, v181
    v_exp_f32 v184, v184
    v_exp_f32 v185, v185
    v_add_f32 v37, v37, v182
    v_add_f32 v39, v39, v183
    v_cvt_pk_bf16_f32 v203, v182, v183
    v_exp_f32 v186, v186
    v_exp_f32 v187, v187
    v_add_f32 v37, v37, v184
    v_add_f32 v39, v39, v185
    v_cvt_pk_bf16_f32 v204, v184, v185
    v_exp_f32 v188, v188
    v_exp_f32 v189, v189
    v_add_f32 v37, v37, v186
    v_add_f32 v39, v39, v187
    v_cvt_pk_bf16_f32 v205, v186, v187
    v_exp_f32 v190, v190
    v_exp_f32 v191, v191
    v_add_f32 v37, v37, v188
    v_add_f32 v39, v39, v189
    v_cvt_pk_bf16_f32 v206, v188, v189
    v_add_f32 v37, v37, v190
    v_add_f32 v39, v39, v191
    v_cvt_pk_bf16_f32 v207, v190, v191
    ds_read_b128 v[208:211], v10 offset:0
    ds_read_b64_tr_b16 v[224:225], v30 offset:49152
    ds_read_b64_tr_b16 v[226:227], v30 offset:51200
    ds_read_b128 v[212:215], v11 offset:0
    ds_read_b64_tr_b16 v[228:229], v31 offset:49152
    ds_read_b64_tr_b16 v[230:231], v31 offset:51200
    ds_read_b128 v[216:219], v12 offset:0
    ds_read_b64_tr_b16 v[232:233], v32 offset:49152
    ds_read_b64_tr_b16 v[234:235], v32 offset:51200
    ds_read_b128 v[220:223], v13 offset:0
    ds_read_b64_tr_b16 v[236:237], v33 offset:49152
    ds_read_b64_tr_b16 v[238:239], v33 offset:51200
    s_waitcnt vmcnt(4)
    s_barrier
    s_setprio 1
    s_waitcnt lgkmcnt(11)
    v_mfma_f32_32x32x16_bf16 v[160:175], v[208:211], v[48:51], v[144:159]
    ds_read_b128 v[208:211], v14 offset:0
    s_waitcnt lgkmcnt(10)
    v_mfma_f32_32x32x16_bf16 v[80:95], v[224:227], v[192:195], v[80:95]
    ds_read_b64_tr_b16 v[224:225], v30 offset:53248
    ds_read_b64_tr_b16 v[226:227], v30 offset:55296
    s_waitcnt lgkmcnt(11)
    v_mfma_f32_32x32x16_bf16 v[160:175], v[212:215], v[52:55], v[160:175]
    ds_read_b128 v[212:215], v15 offset:0
    s_waitcnt lgkmcnt(10)
    v_mfma_f32_32x32x16_bf16 v[96:111], v[228:231], v[192:195], v[96:111]
    ds_read_b64_tr_b16 v[228:229], v31 offset:53248
    ds_read_b64_tr_b16 v[230:231], v31 offset:55296
    s_waitcnt lgkmcnt(11)
    v_mfma_f32_32x32x16_bf16 v[160:175], v[216:219], v[56:59], v[160:175]
    ds_read_b128 v[216:219], v16 offset:0
    s_waitcnt lgkmcnt(10)
    v_mfma_f32_32x32x16_bf16 v[112:127], v[232:235], v[192:195], v[112:127]
    ds_read_b64_tr_b16 v[232:233], v32 offset:53248
    ds_read_b64_tr_b16 v[234:235], v32 offset:55296
    s_waitcnt lgkmcnt(11)
    v_mfma_f32_32x32x16_bf16 v[160:175], v[220:223], v[60:63], v[160:175]
    ds_read_b128 v[220:223], v17 offset:0
    s_waitcnt lgkmcnt(10)
    v_mfma_f32_32x32x16_bf16 v[128:143], v[236:239], v[192:195], v[128:143]
    ds_read_b64_tr_b16 v[236:237], v33 offset:53248
    ds_read_b64_tr_b16 v[238:239], v33 offset:55296
    s_waitcnt lgkmcnt(11)
    v_mfma_f32_32x32x16_bf16 v[160:175], v[208:211], v[64:67], v[160:175]
    ds_read_b128 v[208:211], v10 offset:8192
    s_waitcnt lgkmcnt(10)
    v_mfma_f32_32x32x16_bf16 v[80:95], v[224:227], v[196:199], v[80:95]
    ds_read_b64_tr_b16 v[224:225], v30 offset:57344
    ds_read_b64_tr_b16 v[226:227], v30 offset:59392
    s_waitcnt lgkmcnt(11)
    v_mfma_f32_32x32x16_bf16 v[160:175], v[212:215], v[68:71], v[160:175]
    ds_read_b128 v[212:215], v11 offset:8192
    s_waitcnt lgkmcnt(10)
    v_mfma_f32_32x32x16_bf16 v[96:111], v[228:231], v[196:199], v[96:111]
    ds_read_b64_tr_b16 v[228:229], v31 offset:57344
    ds_read_b64_tr_b16 v[230:231], v31 offset:59392
    s_waitcnt lgkmcnt(11)
    v_mfma_f32_32x32x16_bf16 v[160:175], v[216:219], v[72:75], v[160:175]
    ds_read_b128 v[216:219], v12 offset:8192
    s_waitcnt lgkmcnt(10)
    v_mfma_f32_32x32x16_bf16 v[112:127], v[232:235], v[196:199], v[112:127]
    ds_read_b64_tr_b16 v[232:233], v32 offset:57344
    ds_read_b64_tr_b16 v[234:235], v32 offset:59392
    s_waitcnt lgkmcnt(11)
    v_mfma_f32_32x32x16_bf16 v[160:175], v[220:223], v[76:79], v[160:175]
    ds_read_b128 v[220:223], v13 offset:8192
    s_waitcnt lgkmcnt(10)
    v_mfma_f32_32x32x16_bf16 v[128:143], v[236:239], v[196:199], v[128:143]
    ds_read_b64_tr_b16 v[236:237], v33 offset:57344
    ds_read_b64_tr_b16 v[238:239], v33 offset:59392
    s_waitcnt lgkmcnt(11)
    v_mfma_f32_32x32x16_bf16 v[176:191], v[208:211], v[48:51], v[144:159]
    ds_read_b128 v[208:211], v14 offset:8192
    s_waitcnt lgkmcnt(10)
    v_mfma_f32_32x32x16_bf16 v[80:95], v[224:227], v[200:203], v[80:95]
    ds_read_b64_tr_b16 v[224:225], v30 offset:61440
    ds_read_b64_tr_b16 v[226:227], v30 offset:63488
    s_waitcnt lgkmcnt(11)
    v_mfma_f32_32x32x16_bf16 v[176:191], v[212:215], v[52:55], v[176:191]
    ds_read_b128 v[212:215], v15 offset:8192
    s_waitcnt lgkmcnt(10)
    v_mfma_f32_32x32x16_bf16 v[96:111], v[228:231], v[200:203], v[96:111]
    ds_read_b64_tr_b16 v[228:229], v31 offset:61440
    ds_read_b64_tr_b16 v[230:231], v31 offset:63488
    s_waitcnt lgkmcnt(11)
    v_mfma_f32_32x32x16_bf16 v[176:191], v[216:219], v[56:59], v[176:191]
    ds_read_b128 v[216:219], v16 offset:8192
    s_waitcnt lgkmcnt(10)
    v_mfma_f32_32x32x16_bf16 v[112:127], v[232:235], v[200:203], v[112:127]
    ds_read_b64_tr_b16 v[232:233], v32 offset:61440
    ds_read_b64_tr_b16 v[234:235], v32 offset:63488
    s_waitcnt lgkmcnt(11)
    v_mfma_f32_32x32x16_bf16 v[176:191], v[220:223], v[60:63], v[176:191]
    ds_read_b128 v[220:223], v17 offset:8192
    s_waitcnt lgkmcnt(10)
    v_mfma_f32_32x32x16_bf16 v[128:143], v[236:239], v[200:203], v[128:143]
    ds_read_b64_tr_b16 v[236:237], v33 offset:61440
    ds_read_b64_tr_b16 v[238:239], v33 offset:63488
    s_waitcnt lgkmcnt(11)
    v_mfma_f32_32x32x16_bf16 v[176:191], v[208:211], v[64:67], v[176:191]
    s_waitcnt lgkmcnt(9)
    v_mfma_f32_32x32x16_bf16 v[80:95], v[224:227], v[204:207], v[80:95]
    s_waitcnt lgkmcnt(8)
    v_mfma_f32_32x32x16_bf16 v[176:191], v[212:215], v[68:71], v[176:191]
    s_waitcnt lgkmcnt(6)
    v_mfma_f32_32x32x16_bf16 v[96:111], v[228:231], v[204:207], v[96:111]
    s_waitcnt lgkmcnt(5)
    v_mfma_f32_32x32x16_bf16 v[176:191], v[216:219], v[72:75], v[176:191]
    s_waitcnt lgkmcnt(3)
    v_mfma_f32_32x32x16_bf16 v[112:127], v[232:235], v[204:207], v[112:127]
    s_waitcnt lgkmcnt(2)
    v_mfma_f32_32x32x16_bf16 v[176:191], v[220:223], v[76:79], v[176:191]
    s_waitcnt lgkmcnt(0)
    v_mfma_f32_32x32x16_bf16 v[128:143], v[236:239], v[204:207], v[128:143]
    s_setprio 0
    s_waitcnt vmcnt(4)
    s_barrier
    s_add_u32 s27, s27, 1
    s_cmp_lt_u32 s27, 3
    s_cbranch_scc1 K1_loop
    s_add_u32 m0, s25, 98304
    s_nop 0
    buffer_load_dwordx4 v34, s[4:7], s26 offen lds
    s_add_u32 m0, s25, 99328
    s_nop 0
    buffer_load_dwordx4 v35, s[4:7], s26 offen lds
    s_add_u32 m0, s25, 81920
    s_nop 0
    buffer_load_dwordx4 v36, s[8:11], s42 offen lds
    buffer_load_dwordx4 v36, s[8:11], s42 offen offset:1024 lds
    s_add_u32 s26, s26, 16384
    s_add_u32 s42, s42, 16384
    v_max3_f32 v38, v160, v161, v162
    v_max3_f32 v38, v38, v163, v164
    v_max3_f32 v38, v38, v165, v166
    v_max3_f32 v38, v38, v167, v168
    v_max3_f32 v38, v38, v169, v170
    v_max3_f32 v38, v38, v171, v172
    v_max3_f32 v38, v38, v173, v174
    v_max3_f32 v38, v38, v175, v176
    v_max3_f32 v38, v38, v177, v178
    v_max3_f32 v38, v38, v179, v180
    v_max3_f32 v38, v38, v181, v182
    v_max3_f32 v38, v38, v183, v184
    v_max3_f32 v38, v38, v185, v186
    v_max3_f32 v38, v38, v187, v188
    v_max3_f32 v38, v38, v189, v190
    v_max_f32 v38, v38, v191
    v_cmp_lt_f32 vcc, s28, v38
    s_nop 4
    s_cbranch_vccz K1_nr_p0
    v_mov_b32 v6, v38
    v_mov_b32 v7, v38
    s_nop 0
    s_nop 0
    v_permlane32_swap_b32 v6, v7
    v_max_f32 v41, v6, v7
    v_max_f32 v41, s29, v41
    v_sub_f32 v42, 0, v41
    v_min_f32 v42, 0x42c80000, v42
    v_exp_f32 v42, v42
    v_sub_f32 v160, v160, v41
    v_sub_f32 v161, v161, v41
    v_sub_f32 v162, v162, v41
    v_sub_f32 v163, v163, v41
    v_sub_f32 v164, v164, v41
    v_sub_f32 v165, v165, v41
    v_sub_f32 v166, v166, v41
    v_sub_f32 v167, v167, v41
    v_sub_f32 v168, v168, v41
    v_sub_f32 v169, v169, v41
    v_sub_f32 v170, v170, v41
    v_sub_f32 v171, v171, v41
    v_sub_f32 v172, v172, v41
    v_sub_f32 v173, v173, v41
    v_sub_f32 v174, v174, v41
    v_sub_f32 v175, v175, v41
    v_sub_f32 v176, v176, v41
    v_sub_f32 v177, v177, v41
    v_sub_f32 v178, v178, v41
    v_sub_f32 v179, v179, v41
    v_sub_f32 v180, v180, v41
    v_sub_f32 v181, v181, v41
    v_sub_f32 v182, v182, v41
    v_sub_f32 v183, v183, v41
    v_sub_f32 v184, v184, v41
    v_sub_f32 v185, v185, v41
    v_sub_f32 v186, v186, v41
    v_sub_f32 v187, v187, v41
    v_sub_f32 v188, v188, v41
    v_sub_f32 v189, v189, v41
    v_sub_f32 v190, v190, v41
    v_sub_f32 v191, v191, v41
    v_sub_f32 v144, v144, v41
    v_sub_f32 v145, v145, v41
    v_sub_f32 v146, v146, v41
    v_sub_f32 v147, v147, v41
    v_sub_f32 v148, v148, v41
    v_sub_f32 v149, v149, v41
    v_sub_f32 v150, v150, v41
    v_sub_f32 v151, v151, v41
    v_sub_f32 v152, v152, v41
    v_sub_f32 v153, v153, v41
    v_sub_f32 v154, v154, v41
    v_sub_f32 v155, v155, v41
    v_sub_f32 v156, v156, v41
    v_sub_f32 v157, v157, v41
    v_sub_f32 v158, v158, v41
    v_sub_f32 v159, v159, v41
    v_mul_f32 v37, v37, v42
    v_mul_f32 v39, v39, v42
    v_mul_f32 v80, v80, v42
    v_mul_f32 v81, v81, v42
    v_mul_f32 v82, v82, v42
    v_mul_f32 v83, v83, v42
    v_mul_f32 v84, v84, v42
    v_mul_f32 v85, v85, v42
    v_mul_f32 v86, v86, v42
    v_mul_f32 v87, v87, v42
    v_mul_f32 v88, v88, v42
    v_mul_f32 v89, v89, v42
    v_mul_f32 v90, v90, v42
    v_mul_f32 v91, v91, v42
    v_mul_f32 v92, v92, v42
    v_mul_f32 v93, v93, v42
    v_mul_f32 v94, v94, v42
    v_mul_f32 v95, v95, v42
    v_mul_f32 v96, v96, v42
    v_mul_f32 v97, v97, v42
    v_mul_f32 v98, v98, v42
    v_mul_f32 v99, v99, v42
    v_mul_f32 v100, v100, v42
    v_mul_f32 v101, v101, v42
    v_mul_f32 v102, v102, v42
    v_mul_f32 v103, v103, v42
    v_mul_f32 v104, v104, v42
    v_mul_f32 v105, v105, v42
    v_mul_f32 v106, v106, v42
    v_mul_f32 v107, v107, v42
    v_mul_f32 v108, v108, v42
    v_mul_f32 v109, v109, v42
    v_mul_f32 v110, v110, v42
    v_mul_f32 v111, v111, v42
    v_mul_f32 v112, v112, v42
    v_mul_f32 v113, v113, v42
    v_mul_f32 v114, v114, v42
    v_mul_f32 v115, v115, v42
    v_mul_f32 v116, v116, v42
    v_mul_f32 v117, v117, v42
    v_mul_f32 v118, v118, v42
    v_mul_f32 v119, v119, v42
    v_mul_f32 v120, v120, v42
    v_mul_f32 v121, v121, v42
    v_mul_f32 v122, v122, v42
    v_mul_f32 v123, v123, v42
    v_mul_f32 v124, v124, v42
    v_mul_f32 v125, v125, v42
    v_mul_f32 v126, v126, v42
    v_mul_f32 v127, v127, v42
    v_mul_f32 v128, v128, v42
    v_mul_f32 v129, v129, v42
    v_mul_f32 v130, v130, v42
    v_mul_f32 v131, v131, v42
    v_mul_f32 v132, v132, v42
    v_mul_f32 v133, v133, v42
    v_mul_f32 v134, v134, v42
    v_mul_f32 v135, v135, v42
    v_mul_f32 v136, v136, v42
    v_mul_f32 v137, v137, v42
    v_mul_f32 v138, v138, v42
    v_mul_f32 v139, v139, v42
    v_mul_f32 v140, v140, v42
    v_mul_f32 v141, v141, v42
    v_mul_f32 v142, v142, v42
    v_mul_f32 v143, v143, v42
    s_nop 15
K1_nr_p0:
    s_mov_b32 s28, 0x41000000
    s_mov_b32 s29, 0
    v_exp_f32 v160, v160
    v_exp_f32 v161, v161
    v_exp_f32 v162, v162
    v_exp_f32 v163, v163
    v_add_f32 v37, v37, v160
    v_add_f32 v39, v39, v161
    v_cvt_pk_bf16_f32 v192, v160, v161
    v_exp_f32 v164, v164
    v_exp_f32 v165, v165
    v_add_f32 v37, v37, v162
    v_add_f32 v39, v39, v163
    v_cvt_pk_bf16_f32 v193, v162, v163
    v_exp_f32 v166, v166
    v_exp_f32 v167, v167
    v_add_f32 v37, v37, v164
    v_add_f32 v39, v39, v165
    v_cvt_pk_bf16_f32 v194, v164, v165
    v_exp_f32 v168, v168
    v_exp_f32 v169, v169
    v_add_f32 v37, v37, v166
    v_add_f32 v39, v39, v167
    v_cvt_pk_bf16_f32 v195, v166, v167
    v_exp_f32 v170, v170
    v_exp_f32 v171, v171
    v_add_f32 v37, v37, v168
    v_add_f32 v39, v39, v169
    v_cvt_pk_bf16_f32 v196, v168, v169
    v_exp_f32 v172, v172
    v_exp_f32 v173, v173
    v_add_f32 v37, v37, v170
    v_add_f32 v39, v39, v171
    v_cvt_pk_bf16_f32 v197, v170, v171
    v_exp_f32 v174, v174
    v_exp_f32 v175, v175
    v_add_f32 v37, v37, v172
    v_add_f32 v39, v39, v173
    v_cvt_pk_bf16_f32 v198, v172, v173
    v_exp_f32 v176, v176
    v_exp_f32 v177, v177
    v_add_f32 v37, v37, v174
    v_add_f32 v39, v39, v175
    v_cvt_pk_bf16_f32 v199, v174, v175
    v_exp_f32 v178, v178
    v_exp_f32 v179, v179
    v_add_f32 v37, v37, v176
    v_add_f32 v39, v39, v177
    v_cvt_pk_bf16_f32 v200, v176, v177
    v_exp_f32 v180, v180
    v_exp_f32 v181, v181
    v_add_f32 v37, v37, v178
    v_add_f32 v39, v39, v179
    v_cvt_pk_bf16_f32 v201, v178, v179
    v_exp_f32 v182, v182
    v_exp_f32 v183, v183
    v_add_f32 v37, v37, v180
    v_add_f32 v39, v39, v181
    v_cvt_pk_bf16_f32 v202, v180, v181
    v_exp_f32 v184, v184
    v_exp_f32 v185, v185
    v_add_f32 v37, v37, v182
    v_add_f32 v39, v39, v183
    v_cvt_pk_bf16_f32 v203, v182, v183
    v_exp_f32 v186, v186
    v_exp_f32 v187, v187
    v_add_f32 v37, v37, v184
    v_add_f32 v39, v39, v185
    v_cvt_pk_bf16_f32 v204, v184, v185
    v_exp_f32 v188, v188
    v_exp_f32 v189, v189
    v_add_f32 v37, v37, v186
    v_add_f32 v39, v39, v187
    v_cvt_pk_bf16_f32 v205, v186, v187
    v_exp_f32 v190, v190
    v_exp_f32 v191, v191
    v_add_f32 v37, v37, v188
    v_add_f32 v39, v39, v189
    v_cvt_pk_bf16_f32 v206, v188, v189
    v_add_f32 v37, v37, v190
    v_add_f32 v39, v39, v191
    v_cvt_pk_bf16_f32 v207, v190, v191
    ds_read_b128 v[208:211], v10 offset:32768
    ds_read_b64_tr_b16 v[224:225], v26 offset:16384
    ds_read_b64_tr_b16 v[226:227], v26 offset:18432
    ds_read_b128 v[212:215], v11 offset:32768
    ds_read_b64_tr_b16 v[228:229], v27 offset:16384
    ds_read_b64_tr_b16 v[230:231], v27 offset:18432
    ds_read_b128 v[216:219], v12 offset:32768
    ds_read_b64_tr_b16 v[232:233], v28 offset:16384
    ds_read_b64_tr_b16 v[234:235], v28 offset:18432
    ds_read_b128 v[220:223], v13 offset:32768
    ds_read_b64_tr_b16 v[236:237], v29 offset:16384
    ds_read_b64_tr_b16 v[238:239], v29 offset:18432
    s_waitcnt vmcnt(4)
    s_barrier
    s_setprio 1
    s_waitcnt lgkmcnt(11)
    v_mfma_f32_32x32x16_bf16 v[160:175], v[208:211], v[48:51], v[144:159]
    ds_read_b128 v[208:211], v14 offset:32768
    s_waitcnt lgkmcnt(10)
    v_mfma_f32_32x32x16_bf16 v[80:95], v[224:227], v[192:195], v[80:95]
    ds_read_b64_tr_b16 v[224:225], v26 offset:20480
    ds_read_b64_tr_b16 v[226:227], v26 offset:22528
    s_waitcnt lgkmcnt(11)
    v_mfma_f32_32x32x16_bf16 v[160:175], v[212:215], v[52:55], v[160:175]
    ds_read_b128 v[212:215], v15 offset:32768
    s_waitcnt lgkmcnt(10)
    v_mfma_f32_32x32x16_bf16 v[96:111], v[228:231], v[192:195], v[96:111]
    ds_read_b64_tr_b16 v[228:229], v27 offset:20480
    ds_read_b64_tr_b16 v[230:231], v27 offset:22528
    s_waitcnt lgkmcnt(11)
    v_mfma_f32_32x32x16_bf16 v[160:175], v[216:219], v[56:59], v[160:175]
    ds_read_b128 v[216:219], v16 offset:32768
    s_waitcnt lgkmcnt(10)
    v_mfma_f32_32x32x16_bf16 v[112:127], v[232:235], v[192:195], v[112:127]
    ds_read_b64_tr_b16 v[232:233], v28 offset:20480
    ds_read_b64_tr_b16 v[234:235], v28 offset:22528
    s_waitcnt lgkmcnt(11)
    v_mfma_f32_32x32x16_bf16 v[160:175], v[220:223], v[60:63], v[160:175]
    ds_read_b128 v[220:223], v17 offset:32768
    s_waitcnt lgkmcnt(10)
    v_mfma_f32_32x32x16_bf16 v[128:143], v[236:239], v[192:195], v[128:143]
    ds_read_b64_tr_b16 v[236:237], v29 offset:20480
    ds_read_b64_tr_b16 v[238:239], v29 offset:22528
    s_waitcnt lgkmcnt(11)
    v_mfma_f32_32x32x16_bf16 v[160:175], v[208:211], v[64:67], v[160:175]
    ds_read_b128 v[208:211], v10 offset:40960
    s_waitcnt lgkmcnt(10)
    v_mfma_f32_32x32x16_bf16 v[80:95], v[224:227], v[196:199], v[80:95]
    ds_read_b64_tr_b16 v[224:225], v26 offset:24576
    ds_read_b64_tr_b16 v[226:227], v26 offset:26624
    s_waitcnt lgkmcnt(11)
    v_mfma_f32_32x32x16_bf16 v[160:175], v[212:215], v[68:71], v[160:175]
    ds_read_b128 v[212:215], v11 offset:40960
    s_waitcnt lgkmcnt(10)
    v_mfma_f32_32x32x16_bf16 v[96:111], v[228:231], v[196:199], v[96:111]
    ds_read_b64_tr_b16 v[228:229], v27 offset:24576
    ds_read_b64_tr_b16 v[230:231], v27 offset:26624
    s_waitcnt lgkmcnt(11)
    v_mfma_f32_32x32x16_bf16 v[160:175], v[216:219], v[72:75], v[160:175]
    ds_read_b128 v[216:219], v12 offset:40960
    s_waitcnt lgkmcnt(10)
    v_mfma_f32_32x32x16_bf16 v[112:127], v[232:235], v[196:199], v[112:127]
    ds_read_b64_tr_b16 v[232:233], v28 offset:24576
    ds_read_b64_tr_b16 v[234:235], v28 offset:26624
    s_waitcnt lgkmcnt(11)
    v_mfma_f32_32x32x16_bf16 v[160:175], v[220:223], v[76:79], v[160:175]
    ds_read_b128 v[220:223], v13 offset:40960
    s_waitcnt lgkmcnt(10)
    v_mfma_f32_32x32x16_bf16 v[128:143], v[236:239], v[196:199], v[128:143]
    ds_read_b64_tr_b16 v[236:237], v29 offset:24576
    ds_read_b64_tr_b16 v[238:239], v29 offset:26624
    s_waitcnt lgkmcnt(11)
    v_mfma_f32_32x32x16_bf16 v[176:191], v[208:211], v[48:51], v[144:159]
    ds_read_b128 v[208:211], v14 offset:40960
    s_waitcnt lgkmcnt(10)
    v_mfma_f32_32x32x16_bf16 v[80:95], v[224:227], v[200:203], v[80:95]
    ds_read_b64_tr_b16 v[224:225], v26 offset:28672
    ds_read_b64_tr_b16 v[226:227], v26 offset:30720
    s_waitcnt lgkmcnt(11)
    v_mfma_f32_32x32x16_bf16 v[176:191], v[212:215], v[52:55], v[176:191]
    ds_read_b128 v[212:215], v15 offset:40960
    s_waitcnt lgkmcnt(10)
    v_mfma_f32_32x32x16_bf16 v[96:111], v[228:231], v[200:203], v[96:111]
    ds_read_b64_tr_b16 v[228:229], v27 offset:28672
    ds_read_b64_tr_b16 v[230:231], v27 offset:30720
    s_waitcnt lgkmcnt(11)
    v_mfma_f32_32x32x16_bf16 v[176:191], v[216:219], v[56:59], v[176:191]
    ds_read_b128 v[216:219], v16 offset:40960
    s_waitcnt lgkmcnt(10)
    v_mfma_f32_32x32x16_bf16 v[112:127], v[232:235], v[200:203], v[112:127]
    ds_read_b64_tr_b16 v[232:233], v28 offset:28672
    ds_read_b64_tr_b16 v[234:235], v28 offset:30720
    s_waitcnt lgkmcnt(11)
    v_mfma_f32_32x32x16_bf16 v[176:191], v[220:223], v[60:63], v[176:191]
    ds_read_b128 v[220:223], v17 offset:40960
    s_waitcnt lgkmcnt(10)
    v_mfma_f32_32x32x16_bf16 v[128:143], v[236:239], v[200:203], v[128:143]
    ds_read_b64_tr_b16 v[236:237], v29 offset:28672
    ds_read_b64_tr_b16 v[238:239], v29 offset:30720
    s_waitcnt lgkmcnt(11)
    v_mfma_f32_32x32x16_bf16 v[176:191], v[208:211], v[64:67], v[176:191]
    s_waitcnt lgkmcnt(9)
    v_mfma_f32_32x32x16_bf16 v[80:95], v[224:227], v[204:207], v[80:95]
    s_waitcnt lgkmcnt(8)
    v_mfma_f32_32x32x16_bf16 v[176:191], v[212:215], v[68:71], v[176:191]
    s_waitcnt lgkmcnt(6)
    v_mfma_f32_32x32x16_bf16 v[96:111], v[228:231], v[204:207], v[96:111]
    s_waitcnt lgkmcnt(5)
    v_mfma_f32_32x32x16_bf16 v[176:191], v[216:219], v[72:75], v[176:191]
    s_waitcnt lgkmcnt(3)
    v_mfma_f32_32x32x16_bf16 v[112:127], v[232:235], v[204:207], v[112:127]
    s_waitcnt lgkmcnt(2)
    v_mfma_f32_32x32x16_bf16 v[176:191], v[220:223], v[76:79], v[176:191]
    s_waitcnt lgkmcnt(0)
    v_mfma_f32_32x32x16_bf16 v[128:143], v[236:239], v[204:207], v[128:143]
    s_setprio 0
    s_waitcnt vmcnt(4)
    s_barrier
    s_add_u32 m0, s25, 0
    s_nop 0
    buffer_load_dwordx4 v34, s[4:7], s26 offen lds
    s_add_u32 m0, s25, 1024
    s_nop 0
    buffer_load_dwordx4 v35, s[4:7], s26 offen lds
    s_add_u32 m0, s25, 114688
    s_nop 0
    buffer_load_dwordx4 v36, s[8:11], s42 offen lds
    buffer_load_dwordx4 v36, s[8:11], s42 offen offset:1024 lds
    s_add_u32 s26, s26, 16384
    s_add_u32 s42, s42, 16384
    v_max3_f32 v38, v160, v161, v162
    v_max3_f32 v38, v38, v163, v164
    v_max3_f32 v38, v38, v165, v166
    v_max3_f32 v38, v38, v167, v168
    v_max3_f32 v38, v38, v169, v170
    v_max3_f32 v38, v38, v171, v172
    v_max3_f32 v38, v38, v173, v174
    v_max3_f32 v38, v38, v175, v176
    v_max3_f32 v38, v38, v177, v178
    v_max3_f32 v38, v38, v179, v180
    v_max3_f32 v38, v38, v181, v182
    v_max3_f32 v38, v38, v183, v184
    v_max3_f32 v38, v38, v185, v186
    v_max3_f32 v38, v38, v187, v188
    v_max3_f32 v38, v38, v189, v190
    v_max_f32 v38, v38, v191
    v_cmp_lt_f32 vcc, s28, v38
    s_nop 4
    s_cbranch_vccz K1_nr_p1
    v_mov_b32 v6, v38
    v_mov_b32 v7, v38
    s_nop 0
    s_nop 0
    v_permlane32_swap_b32 v6, v7
    v_max_f32 v41, v6, v7
    v_max_f32 v41, s29, v41
    v_sub_f32 v42, 0, v41
    v_min_f32 v42, 0x42c80000, v42
    v_exp_f32 v42, v42
    v_sub_f32 v160, v160, v41
    v_sub_f32 v161, v161, v41
    v_sub_f32 v162, v162, v41
    v_sub_f32 v163, v163, v41
    v_sub_f32 v164, v164, v41
    v_sub_f32 v165, v165, v41
    v_sub_f32 v166, v166, v41
    v_sub_f32 v167, v167, v41
    v_sub_f32 v168, v168, v41
    v_sub_f32 v169, v169, v41
    v_sub_f32 v170, v170, v41
    v_sub_f32 v171, v171, v41
    v_sub_f32 v172, v172, v41
    v_sub_f32 v173, v173, v41
    v_sub_f32 v174, v174, v41
    v_sub_f32 v175, v175, v41
    v_sub_f32 v176, v176, v41
    v_sub_f32 v177, v177, v41
    v_sub_f32 v178, v178, v41
    v_sub_f32 v179, v179, v41
    v_sub_f32 v180, v180, v41
    v_sub_f32 v181, v181, v41
    v_sub_f32 v182, v182, v41
    v_sub_f32 v183, v183, v41
    v_sub_f32 v184, v184, v41
    v_sub_f32 v185, v185, v41
    v_sub_f32 v186, v186, v41
    v_sub_f32 v187, v187, v41
    v_sub_f32 v188, v188, v41
    v_sub_f32 v189, v189, v41
    v_sub_f32 v190, v190, v41
    v_sub_f32 v191, v191, v41
    v_sub_f32 v144, v144, v41
    v_sub_f32 v145, v145, v41
    v_sub_f32 v146, v146, v41
    v_sub_f32 v147, v147, v41
    v_sub_f32 v148, v148, v41
    v_sub_f32 v149, v149, v41
    v_sub_f32 v150, v150, v41
    v_sub_f32 v151, v151, v41
    v_sub_f32 v152, v152, v41
    v_sub_f32 v153, v153, v41
    v_sub_f32 v154, v154, v41
    v_sub_f32 v155, v155, v41
    v_sub_f32 v156, v156, v41
    v_sub_f32 v157, v157, v41
    v_sub_f32 v158, v158, v41
    v_sub_f32 v159, v159, v41
    v_mul_f32 v37, v37, v42
    v_mul_f32 v39, v39, v42
    v_mul_f32 v80, v80, v42
    v_mul_f32 v81, v81, v42
    v_mul_f32 v82, v82, v42
    v_mul_f32 v83, v83, v42
    v_mul_f32 v84, v84, v42
    v_mul_f32 v85, v85, v42
    v_mul_f32 v86, v86, v42
    v_mul_f32 v87, v87, v42
    v_mul_f32 v88, v88, v42
    v_mul_f32 v89, v89, v42
    v_mul_f32 v90, v90, v42
    v_mul_f32 v91, v91, v42
    v_mul_f32 v92, v92, v42
    v_mul_f32 v93, v93, v42
    v_mul_f32 v94, v94, v42
    v_mul_f32 v95, v95, v42
    v_mul_f32 v96, v96, v42
    v_mul_f32 v97, v97, v42
    v_mul_f32 v98, v98, v42
    v_mul_f32 v99, v99, v42
    v_mul_f32 v100, v100, v42
    v_mul_f32 v101, v101, v42
    v_mul_f32 v102, v102, v42
    v_mul_f32 v103, v103, v42
    v_mul_f32 v104, v104, v42
    v_mul_f32 v105, v105, v42
    v_mul_f32 v106, v106, v42
    v_mul_f32 v107, v107, v42
    v_mul_f32 v108, v108, v42
    v_mul_f32 v109, v109, v42
    v_mul_f32 v110, v110, v42
    v_mul_f32 v111, v111, v42
    v_mul_f32 v112, v112, v42
    v_mul_f32 v113, v113, v42
    v_mul_f32 v114, v114, v42
    v_mul_f32 v115, v115, v42
    v_mul_f32 v116, v116, v42
    v_mul_f32 v117, v117, v42
    v_mul_f32 v118, v118, v42
    v_mul_f32 v119, v119, v42
    v_mul_f32 v120, v120, v42
    v_mul_f32 v121, v121, v42
    v_mul_f32 v122, v122, v42
    v_mul_f32 v123, v123, v42
    v_mul_f32 v124, v124, v42
    v_mul_f32 v125, v125, v42
    v_mul_f32 v126, v126, v42
    v_mul_f32 v127, v127, v42
    v_mul_f32 v128, v128, v42
    v_mul_f32 v129, v129, v42
    v_mul_f32 v130, v130, v42
    v_mul_f32 v131, v131, v42
    v_mul_f32 v132, v132, v42
    v_mul_f32 v133, v133, v42
    v_mul_f32 v134, v134, v42
    v_mul_f32 v135, v135, v42
    v_mul_f32 v136, v136, v42
    v_mul_f32 v137, v137, v42
    v_mul_f32 v138, v138, v42
    v_mul_f32 v139, v139, v42
    v_mul_f32 v140, v140, v42
    v_mul_f32 v141, v141, v42
    v_mul_f32 v142, v142, v42
    v_mul_f32 v143, v143, v42
    s_nop 15
K1_nr_p1:
    s_mov_b32 s28, 0x41000000
    s_mov_b32 s29, 0
    v_exp_f32 v160, v160
    v_exp_f32 v161, v161
    v_exp_f32 v162, v162
    v_exp_f32 v163, v163
    v_add_f32 v37, v37, v160
    v_add_f32 v39, v39, v161
    v_cvt_pk_bf16_f32 v192, v160, v161
    v_exp_f32 v164, v164
    v_exp_f32 v165, v165
    v_add_f32 v37, v37, v162
    v_add_f32 v39, v39, v163
    v_cvt_pk_bf16_f32 v193, v162, v163
    v_exp_f32 v166, v166
    v_exp_f32 v167, v167
    v_add_f32 v37, v37, v164
    v_add_f32 v39, v39, v165
    v_cvt_pk_bf16_f32 v194, v164, v165
    v_exp_f32 v168, v168
    v_exp_f32 v169, v169
    v_add_f32 v37, v37, v166
    v_add_f32 v39, v39, v167
    v_cvt_pk_bf16_f32 v195, v166, v167
    v_exp_f32 v170, v170
    v_exp_f32 v171, v171
    v_add_f32 v37, v37, v168
    v_add_f32 v39, v39, v169
    v_cvt_pk_bf16_f32 v196, v168, v169
    v_exp_f32 v172, v172
    v_exp_f32 v173, v173
    v_add_f32 v37, v37, v170
    v_add_f32 v39, v39, v171
    v_cvt_pk_bf16_f32 v197, v170, v171
    v_exp_f32 v174, v174
    v_exp_f32 v175, v175
    v_add_f32 v37, v37, v172
    v_add_f32 v39, v39, v173
    v_cvt_pk_bf16_f32 v198, v172, v173
    v_exp_f32 v176, v176
    v_exp_f32 v177, v177
    v_add_f32 v37, v37, v174
    v_add_f32 v39, v39, v175
    v_cvt_pk_bf16_f32 v199, v174, v175
    v_exp_f32 v178, v178
    v_exp_f32 v179, v179
    v_add_f32 v37, v37, v176
    v_add_f32 v39, v39, v177
    v_cvt_pk_bf16_f32 v200, v176, v177
    v_exp_f32 v180, v180
    v_exp_f32 v181, v181
    v_add_f32 v37, v37, v178
    v_add_f32 v39, v39, v179
    v_cvt_pk_bf16_f32 v201, v178, v179
    v_exp_f32 v182, v182
    v_exp_f32 v183, v183
    v_add_f32 v37, v37, v180
    v_add_f32 v39, v39, v181
    v_cvt_pk_bf16_f32 v202, v180, v181
    v_exp_f32 v184, v184
    v_exp_f32 v185, v185
    v_add_f32 v37, v37, v182
    v_add_f32 v39, v39, v183
    v_cvt_pk_bf16_f32 v203, v182, v183
    v_exp_f32 v186, v186
    v_exp_f32 v187, v187
    v_add_f32 v37, v37, v184
    v_add_f32 v39, v39, v185
    v_cvt_pk_bf16_f32 v204, v184, v185
    v_exp_f32 v188, v188
    v_exp_f32 v189, v189
    v_add_f32 v37, v37, v186
    v_add_f32 v39, v39, v187
    v_cvt_pk_bf16_f32 v205, v186, v187
    v_exp_f32 v190, v190
    v_exp_f32 v191, v191
    v_add_f32 v37, v37, v188
    v_add_f32 v39, v39, v189
    v_cvt_pk_bf16_f32 v206, v188, v189
    v_add_f32 v37, v37, v190
    v_add_f32 v39, v39, v191
    v_cvt_pk_bf16_f32 v207, v190, v191
    ds_read_b128 v[208:211], v18 offset:0
    ds_read_b64_tr_b16 v[224:225], v26 offset:49152
    ds_read_b64_tr_b16 v[226:227], v26 offset:51200
    ds_read_b128 v[212:215], v19 offset:0
    ds_read_b64_tr_b16 v[228:229], v27 offset:49152
    ds_read_b64_tr_b16 v[230:231], v27 offset:51200
    ds_read_b128 v[216:219], v20 offset:0
    ds_read_b64_tr_b16 v[232:233], v28 offset:49152
    ds_read_b64_tr_b16 v[234:235], v28 offset:51200
    ds_read_b128 v[220:223], v21 offset:0
    ds_read_b64_tr_b16 v[236:237], v29 offset:49152
    ds_read_b64_tr_b16 v[238:239], v29 offset:51200
    s_waitcnt vmcnt(4)
    s_barrier
    s_setprio 1
    s_waitcnt lgkmcnt(11)
    v_mfma_f32_32x32x16_bf16 v[160:175], v[208:211], v[48:51], v[144:159]
    ds_read_b128 v[208:211], v22 offset:0
    s_waitcnt lgkmcnt(10)
    v_mfma_f32_32x32x16_bf16 v[80:95], v[224:227], v[192:195], v[80:95]
    ds_read_b64_tr_b16 v[224:225], v26 offset:53248
    ds_read_b64_tr_b16 v[226:227], v26 offset:55296
    s_waitcnt lgkmcnt(11)
    v_mfma_f32_32x32x16_bf16 v[160:175], v[212:215], v[52:55], v[160:175]
    ds_read_b128 v[212:215], v23 offset:0
    s_waitcnt lgkmcnt(10)
    v_mfma_f32_32x32x16_bf16 v[96:111], v[228:231], v[192:195], v[96:111]
    ds_read_b64_tr_b16 v[228:229], v27 offset:53248
    ds_read_b64_tr_b16 v[230:231], v27 offset:55296
    s_waitcnt lgkmcnt(11)
    v_mfma_f32_32x32x16_bf16 v[160:175], v[216:219], v[56:59], v[160:175]
    ds_read_b128 v[216:219], v24 offset:0
    s_waitcnt lgkmcnt(10)
    v_mfma_f32_32x32x16_bf16 v[112:127], v[232:235], v[192:195], v[112:127]
    ds_read_b64_tr_b16 v[232:233], v28 offset:53248
    ds_read_b64_tr_b16 v[234:235], v28 offset:55296
    s_waitcnt lgkmcnt(11)
    v_mfma_f32_32x32x16_bf16 v[160:175], v[220:223], v[60:63], v[160:175]
    ds_read_b128 v[220:223], v25 offset:0
    s_waitcnt lgkmcnt(10)
    v_mfma_f32_32x32x16_bf16 v[128:143], v[236:239], v[192:195], v[128:143]
    ds_read_b64_tr_b16 v[236:237], v29 offset:53248
    ds_read_b64_tr_b16 v[238:239], v29 offset:55296
    s_waitcnt lgkmcnt(11)
    v_mfma_f32_32x32x16_bf16 v[160:175], v[208:211], v[64:67], v[160:175]
    ds_read_b128 v[208:211], v18 offset:8192
    s_waitcnt lgkmcnt(10)
    v_mfma_f32_32x32x16_bf16 v[80:95], v[224:227], v[196:199], v[80:95]
    ds_read_b64_tr_b16 v[224:225], v26 offset:57344
    ds_read_b64_tr_b16 v[226:227], v26 offset:59392
    s_waitcnt lgkmcnt(11)
    v_mfma_f32_32x32x16_bf16 v[160:175], v[212:215], v[68:71], v[160:175]
    ds_read_b128 v[212:215], v19 offset:8192
    s_waitcnt lgkmcnt(10)
    v_mfma_f32_32x32x16_bf16 v[96:111], v[228:231], v[196:199], v[96:111]
    ds_read_b64_tr_b16 v[228:229], v27 offset:57344
    ds_read_b64_tr_b16 v[230:231], v27 offset:59392
    s_waitcnt lgkmcnt(11)
    v_mfma_f32_32x32x16_bf16 v[160:175], v[216:219], v[72:75], v[160:175]
    ds_read_b128 v[216:219], v20 offset:8192
    s_waitcnt lgkmcnt(10)
    v_mfma_f32_32x32x16_bf16 v[112:127], v[232:235], v[196:199], v[112:127]
    ds_read_b64_tr_b16 v[232:233], v28 offset:57344
    ds_read_b64_tr_b16 v[234:235], v28 offset:59392
    s_waitcnt lgkmcnt(11)
    v_mfma_f32_32x32x16_bf16 v[160:175], v[220:223], v[76:79], v[160:175]
    ds_read_b128 v[220:223], v21 offset:8192
    s_waitcnt lgkmcnt(10)
    v_mfma_f32_32x32x16_bf16 v[128:143], v[236:239], v[196:199], v[128:143]
    ds_read_b64_tr_b16 v[236:237], v29 offset:57344
    ds_read_b64_tr_b16 v[238:239], v29 offset:59392
    s_waitcnt lgkmcnt(11)
    v_mfma_f32_32x32x16_bf16 v[176:191], v[208:211], v[48:51], v[144:159]
    ds_read_b128 v[208:211], v22 offset:8192
    s_waitcnt lgkmcnt(10)
    v_mfma_f32_32x32x16_bf16 v[80:95], v[224:227], v[200:203], v[80:95]
    ds_read_b64_tr_b16 v[224:225], v26 offset:61440
    ds_read_b64_tr_b16 v[226:227], v26 offset:63488
    s_waitcnt lgkmcnt(11)
    v_mfma_f32_32x32x16_bf16 v[176:191], v[212:215], v[52:55], v[176:191]
    ds_read_b128 v[212:215], v23 offset:8192
    s_waitcnt lgkmcnt(10)
    v_mfma_f32_32x32x16_bf16 v[96:111], v[228:231], v[200:203], v[96:111]
    ds_read_b64_tr_b16 v[228:229], v27 offset:61440
    ds_read_b64_tr_b16 v[230:231], v27 offset:63488
    s_waitcnt lgkmcnt(11)
    v_mfma_f32_32x32x16_bf16 v[176:191], v[216:219], v[56:59], v[176:191]
    ds_read_b128 v[216:219], v24 offset:8192
    s_waitcnt lgkmcnt(10)
    v_mfma_f32_32x32x16_bf16 v[112:127], v[232:235], v[200:203], v[112:127]
    ds_read_b64_tr_b16 v[232:233], v28 offset:61440
    ds_read_b64_tr_b16 v[234:235], v28 offset:63488
    s_waitcnt lgkmcnt(11)
    v_mfma_f32_32x32x16_bf16 v[176:191], v[220:223], v[60:63], v[176:191]
    ds_read_b128 v[220:223], v25 offset:8192
    s_waitcnt lgkmcnt(10)
    v_mfma_f32_32x32x16_bf16 v[128:143], v[236:239], v[200:203], v[128:143]
    ds_read_b64_tr_b16 v[236:237], v29 offset:61440
    ds_read_b64_tr_b16 v[238:239], v29 offset:63488
    s_waitcnt lgkmcnt(11)
    v_mfma_f32_32x32x16_bf16 v[176:191], v[208:211], v[64:67], v[176:191]
    s_waitcnt lgkmcnt(9)
    v_mfma_f32_32x32x16_bf16 v[80:95], v[224:227], v[204:207], v[80:95]
    s_waitcnt lgkmcnt(8)
    v_mfma_f32_32x32x16_bf16 v[176:191], v[212:215], v[68:71], v[176:191]
    s_waitcnt lgkmcnt(6)
    v_mfma_f32_32x32x16_bf16 v[96:111], v[228:231], v[204:207], v[96:111]
    s_waitcnt lgkmcnt(5)
    v_mfma_f32_32x32x16_bf16 v[176:191], v[216:219], v[72:75], v[176:191]
    s_waitcnt lgkmcnt(3)
    v_mfma_f32_32x32x16_bf16 v[112:127], v[232:235], v[204:207], v[112:127]
    s_waitcnt lgkmcnt(2)
    v_mfma_f32_32x32x16_bf16 v[176:191], v[220:223], v[76:79], v[176:191]
    s_waitcnt lgkmcnt(0)
    v_mfma_f32_32x32x16_bf16 v[128:143], v[236:239], v[204:207], v[128:143]
    s_setprio 0
    s_waitcnt vmcnt(4)
    s_barrier
    s_add_u32 m0, s25, 32768
    s_nop 0
    buffer_load_dwordx4 v34, s[4:7], s26 offen lds
    s_add_u32 m0, s25, 33792
    s_nop 0
    buffer_load_dwordx4 v35, s[4:7], s26 offen lds
    s_add_u32 m0, s25, 16384
    s_nop 0
    buffer_load_dwordx4 v36, s[8:11], s42 offen lds
    buffer_load_dwordx4 v36, s[8:11], s42 offen offset:1024 lds
    s_add_u32 s26, s26, 16384
    s_add_u32 s42, s42, 16384
    v_max3_f32 v38, v160, v161, v162
    v_max3_f32 v38, v38, v163, v164
    v_max3_f32 v38, v38, v165, v166
    v_max3_f32 v38, v38, v167, v168
    v_max3_f32 v38, v38, v169, v170
    v_max3_f32 v38, v38, v171, v172
    v_max3_f32 v38, v38, v173, v174
    v_max3_f32 v38, v38, v175, v176
    v_max3_f32 v38, v38, v177, v178
    v_max3_f32 v38, v38, v179, v180
    v_max3_f32 v38, v38, v181, v182
    v_max3_f32 v38, v38, v183, v184
    v_max3_f32 v38, v38, v185, v186
    v_max3_f32 v38, v38, v187, v188
    v_max3_f32 v38, v38, v189, v190
    v_max_f32 v38, v38, v191
    v_cmp_lt_f32 vcc, s28, v38
    s_nop 4
    s_cbranch_vccz K1_nr_p2
    v_mov_b32 v6, v38
    v_mov_b32 v7, v38
    s_nop 0
    s_nop 0
    v_permlane32_swap_b32 v6, v7
    v_max_f32 v41, v6, v7
    v_max_f32 v41, s29, v41
    v_sub_f32 v42, 0, v41
    v_min_f32 v42, 0x42c80000, v42
    v_exp_f32 v42, v42
    v_sub_f32 v160, v160, v41
    v_sub_f32 v161, v161, v41
    v_sub_f32 v162, v162, v41
    v_sub_f32 v163, v163, v41
    v_sub_f32 v164, v164, v41
    v_sub_f32 v165, v165, v41
    v_sub_f32 v166, v166, v41
    v_sub_f32 v167, v167, v41
    v_sub_f32 v168, v168, v41
    v_sub_f32 v169, v169, v41
    v_sub_f32 v170, v170, v41
    v_sub_f32 v171, v171, v41
    v_sub_f32 v172, v172, v41
    v_sub_f32 v173, v173, v41
    v_sub_f32 v174, v174, v41
    v_sub_f32 v175, v175, v41
    v_sub_f32 v176, v176, v41
    v_sub_f32 v177, v177, v41
    v_sub_f32 v178, v178, v41
    v_sub_f32 v179, v179, v41
    v_sub_f32 v180, v180, v41
    v_sub_f32 v181, v181, v41
    v_sub_f32 v182, v182, v41
    v_sub_f32 v183, v183, v41
    v_sub_f32 v184, v184, v41
    v_sub_f32 v185, v185, v41
    v_sub_f32 v186, v186, v41
    v_sub_f32 v187, v187, v41
    v_sub_f32 v188, v188, v41
    v_sub_f32 v189, v189, v41
    v_sub_f32 v190, v190, v41
    v_sub_f32 v191, v191, v41
    v_sub_f32 v144, v144, v41
    v_sub_f32 v145, v145, v41
    v_sub_f32 v146, v146, v41
    v_sub_f32 v147, v147, v41
    v_sub_f32 v148, v148, v41
    v_sub_f32 v149, v149, v41
    v_sub_f32 v150, v150, v41
    v_sub_f32 v151, v151, v41
    v_sub_f32 v152, v152, v41
    v_sub_f32 v153, v153, v41
    v_sub_f32 v154, v154, v41
    v_sub_f32 v155, v155, v41
    v_sub_f32 v156, v156, v41
    v_sub_f32 v157, v157, v41
    v_sub_f32 v158, v158, v41
    v_sub_f32 v159, v159, v41
    v_mul_f32 v37, v37, v42
    v_mul_f32 v39, v39, v42
    v_mul_f32 v80, v80, v42
    v_mul_f32 v81, v81, v42
    v_mul_f32 v82, v82, v42
    v_mul_f32 v83, v83, v42
    v_mul_f32 v84, v84, v42
    v_mul_f32 v85, v85, v42
    v_mul_f32 v86, v86, v42
    v_mul_f32 v87, v87, v42
    v_mul_f32 v88, v88, v42
    v_mul_f32 v89, v89, v42
    v_mul_f32 v90, v90, v42
    v_mul_f32 v91, v91, v42
    v_mul_f32 v92, v92, v42
    v_mul_f32 v93, v93, v42
    v_mul_f32 v94, v94, v42
    v_mul_f32 v95, v95, v42
    v_mul_f32 v96, v96, v42
    v_mul_f32 v97, v97, v42
    v_mul_f32 v98, v98, v42
    v_mul_f32 v99, v99, v42
    v_mul_f32 v100, v100, v42
    v_mul_f32 v101, v101, v42
    v_mul_f32 v102, v102, v42
    v_mul_f32 v103, v103, v42
    v_mul_f32 v104, v104, v42
    v_mul_f32 v105, v105, v42
    v_mul_f32 v106, v106, v42
    v_mul_f32 v107, v107, v42
    v_mul_f32 v108, v108, v42
    v_mul_f32 v109, v109, v42
    v_mul_f32 v110, v110, v42
    v_mul_f32 v111, v111, v42
    v_mul_f32 v112, v112, v42
    v_mul_f32 v113, v113, v42
    v_mul_f32 v114, v114, v42
    v_mul_f32 v115, v115, v42
    v_mul_f32 v116, v116, v42
    v_mul_f32 v117, v117, v42
    v_mul_f32 v118, v118, v42
    v_mul_f32 v119, v119, v42
    v_mul_f32 v120, v120, v42
    v_mul_f32 v121, v121, v42
    v_mul_f32 v122, v122, v42
    v_mul_f32 v123, v123, v42
    v_mul_f32 v124, v124, v42
    v_mul_f32 v125, v125, v42
    v_mul_f32 v126, v126, v42
    v_mul_f32 v127, v127, v42
    v_mul_f32 v128, v128, v42
    v_mul_f32 v129, v129, v42
    v_mul_f32 v130, v130, v42
    v_mul_f32 v131, v131, v42
    v_mul_f32 v132, v132, v42
    v_mul_f32 v133, v133, v42
    v_mul_f32 v134, v134, v42
    v_mul_f32 v135, v135, v42
    v_mul_f32 v136, v136, v42
    v_mul_f32 v137, v137, v42
    v_mul_f32 v138, v138, v42
    v_mul_f32 v139, v139, v42
    v_mul_f32 v140, v140, v42
    v_mul_f32 v141, v141, v42
    v_mul_f32 v142, v142, v42
    v_mul_f32 v143, v143, v42
    s_nop 15
K1_nr_p2:
    s_mov_b32 s28, 0x41000000
    s_mov_b32 s29, 0
    v_exp_f32 v160, v160
    v_exp_f32 v161, v161
    v_exp_f32 v162, v162
    v_exp_f32 v163, v163
    v_add_f32 v37, v37, v160
    v_add_f32 v39, v39, v161
    v_cvt_pk_bf16_f32 v192, v160, v161
    v_exp_f32 v164, v164
    v_exp_f32 v165, v165
    v_add_f32 v37, v37, v162
    v_add_f32 v39, v39, v163
    v_cvt_pk_bf16_f32 v193, v162, v163
    v_exp_f32 v166, v166
    v_exp_f32 v167, v167
    v_add_f32 v37, v37, v164
    v_add_f32 v39, v39, v165
    v_cvt_pk_bf16_f32 v194, v164, v165
    v_exp_f32 v168, v168
    v_exp_f32 v169, v169
    v_add_f32 v37, v37, v166
    v_add_f32 v39, v39, v167
    v_cvt_pk_bf16_f32 v195, v166, v167
    v_exp_f32 v170, v170
    v_exp_f32 v171, v171
    v_add_f32 v37, v37, v168
    v_add_f32 v39, v39, v169
    v_cvt_pk_bf16_f32 v196, v168, v169
    v_exp_f32 v172, v172
    v_exp_f32 v173, v173
    v_add_f32 v37, v37, v170
    v_add_f32 v39, v39, v171
    v_cvt_pk_bf16_f32 v197, v170, v171
    v_exp_f32 v174, v174
    v_exp_f32 v175, v175
    v_add_f32 v37, v37, v172
    v_add_f32 v39, v39, v173
    v_cvt_pk_bf16_f32 v198, v172, v173
    v_exp_f32 v176, v176
    v_exp_f32 v177, v177
    v_add_f32 v37, v37, v174
    v_add_f32 v39, v39, v175
    v_cvt_pk_bf16_f32 v199, v174, v175
    v_exp_f32 v178, v178
    v_exp_f32 v179, v179
    v_add_f32 v37, v37, v176
    v_add_f32 v39, v39, v177
    v_cvt_pk_bf16_f32 v200, v176, v177
    v_exp_f32 v180, v180
    v_exp_f32 v181, v181
    v_add_f32 v37, v37, v178
    v_add_f32 v39, v39, v179
    v_cvt_pk_bf16_f32 v201, v178, v179
    v_exp_f32 v182, v182
    v_exp_f32 v183, v183
    v_add_f32 v37, v37, v180
    v_add_f32 v39, v39, v181
    v_cvt_pk_bf16_f32 v202, v180, v181
    v_exp_f32 v184, v184
    v_exp_f32 v185, v185
    v_add_f32 v37, v37, v182
    v_add_f32 v39, v39, v183
    v_cvt_pk_bf16_f32 v203, v182, v183
    v_exp_f32 v186, v186
    v_exp_f32 v187, v187
    v_add_f32 v37, v37, v184
    v_add_f32 v39, v39, v185
    v_cvt_pk_bf16_f32 v204, v184, v185
    v_exp_f32 v188, v188
    v_exp_f32 v189, v189
    v_add_f32 v37, v37, v186
    v_add_f32 v39, v39, v187
    v_cvt_pk_bf16_f32 v205, v186, v187
    v_exp_f32 v190, v190
    v_exp_f32 v191, v191
    v_add_f32 v37, v37, v188
    v_add_f32 v39, v39, v189
    v_cvt_pk_bf16_f32 v206, v188, v189
    v_add_f32 v37, v37, v190
    v_add_f32 v39, v39, v191
    v_cvt_pk_bf16_f32 v207, v190, v191
    ds_read_b128 v[208:211], v18 offset:32768
    ds_read_b64_tr_b16 v[224:225], v30 offset:16384
    ds_read_b64_tr_b16 v[226:227], v30 offset:18432
    ds_read_b128 v[212:215], v19 offset:32768
    ds_read_b64_tr_b16 v[228:229], v31 offset:16384
    ds_read_b64_tr_b16 v[230:231], v31 offset:18432
    ds_read_b128 v[216:219], v20 offset:32768
    ds_read_b64_tr_b16 v[232:233], v32 offset:16384
    ds_read_b64_tr_b16 v[234:235], v32 offset:18432
    ds_read_b128 v[220:223], v21 offset:32768
    ds_read_b64_tr_b16 v[236:237], v33 offset:16384
    ds_read_b64_tr_b16 v[238:239], v33 offset:18432
    s_waitcnt vmcnt(4)
    s_barrier
    s_setprio 1
    s_waitcnt lgkmcnt(11)
    v_mfma_f32_32x32x16_bf16 v[160:175], v[208:211], v[48:51], v[144:159]
    ds_read_b128 v[208:211], v22 offset:32768
    s_waitcnt lgkmcnt(10)
    v_mfma_f32_32x32x16_bf16 v[80:95], v[224:227], v[192:195], v[80:95]
    ds_read_b64_tr_b16 v[224:225], v30 offset:20480
    ds_read_b64_tr_b16 v[226:227], v30 offset:22528
    s_waitcnt lgkmcnt(11)
    v_mfma_f32_32x32x16_bf16 v[160:175], v[212:215], v[52:55], v[160:175]
    ds_read_b128 v[212:215], v23 offset:32768
    s_waitcnt lgkmcnt(10)
    v_mfma_f32_32x32x16_bf16 v[96:111], v[228:231], v[192:195], v[96:111]
    ds_read_b64_tr_b16 v[228:229], v31 offset:20480
    ds_read_b64_tr_b16 v[230:231], v31 offset:22528
    s_waitcnt lgkmcnt(11)
    v_mfma_f32_32x32x16_bf16 v[160:175], v[216:219], v[56:59], v[160:175]
    ds_read_b128 v[216:219], v24 offset:32768
    s_waitcnt lgkmcnt(10)
    v_mfma_f32_32x32x16_bf16 v[112:127], v[232:235], v[192:195], v[112:127]
    ds_read_b64_tr_b16 v[232:233], v32 offset:20480
    ds_read_b64_tr_b16 v[234:235], v32 offset:22528
    s_waitcnt lgkmcnt(11)
    v_mfma_f32_32x32x16_bf16 v[160:175], v[220:223], v[60:63], v[160:175]
    ds_read_b128 v[220:223], v25 offset:32768
    s_waitcnt lgkmcnt(10)
    v_mfma_f32_32x32x16_bf16 v[128:143], v[236:239], v[192:195], v[128:143]
    ds_read_b64_tr_b16 v[236:237], v33 offset:20480
    ds_read_b64_tr_b16 v[238:239], v33 offset:22528
    s_waitcnt lgkmcnt(11)
    v_mfma_f32_32x32x16_bf16 v[160:175], v[208:211], v[64:67], v[160:175]
    ds_read_b128 v[208:211], v18 offset:40960
    s_waitcnt lgkmcnt(10)
    v_mfma_f32_32x32x16_bf16 v[80:95], v[224:227], v[196:199], v[80:95]
    ds_read_b64_tr_b16 v[224:225], v30 offset:24576
    ds_read_b64_tr_b16 v[226:227], v30 offset:26624
    s_waitcnt lgkmcnt(11)
    v_mfma_f32_32x32x16_bf16 v[160:175], v[212:215], v[68:71], v[160:175]
    ds_read_b128 v[212:215], v19 offset:40960
    s_waitcnt lgkmcnt(10)
    v_mfma_f32_32x32x16_bf16 v[96:111], v[228:231], v[196:199], v[96:111]
    ds_read_b64_tr_b16 v[228:229], v31 offset:24576
    ds_read_b64_tr_b16 v[230:231], v31 offset:26624
    s_waitcnt lgkmcnt(11)
    v_mfma_f32_32x32x16_bf16 v[160:175], v[216:219], v[72:75], v[160:175]
    ds_read_b128 v[216:219], v20 offset:40960
    s_waitcnt lgkmcnt(10)
    v_mfma_f32_32x32x16_bf16 v[112:127], v[232:235], v[196:199], v[112:127]
    ds_read_b64_tr_b16 v[232:233], v32 offset:24576
    ds_read_b64_tr_b16 v[234:235], v32 offset:26624
    s_waitcnt lgkmcnt(11)
    v_mfma_f32_32x32x16_bf16 v[160:175], v[220:223], v[76:79], v[160:175]
    ds_read_b128 v[220:223], v21 offset:40960
    s_waitcnt lgkmcnt(10)
    v_mfma_f32_32x32x16_bf16 v[128:143], v[236:239], v[196:199], v[128:143]
    ds_read_b64_tr_b16 v[236:237], v33 offset:24576
    ds_read_b64_tr_b16 v[238:239], v33 offset:26624
    s_waitcnt lgkmcnt(11)
    v_mfma_f32_32x32x16_bf16 v[176:191], v[208:211], v[48:51], v[144:159]
    ds_read_b128 v[208:211], v22 offset:40960
    s_waitcnt lgkmcnt(10)
    v_mfma_f32_32x32x16_bf16 v[80:95], v[224:227], v[200:203], v[80:95]
    ds_read_b64_tr_b16 v[224:225], v30 offset:28672
    ds_read_b64_tr_b16 v[226:227], v30 offset:30720
    s_waitcnt lgkmcnt(11)
    v_mfma_f32_32x32x16_bf16 v[176:191], v[212:215], v[52:55], v[176:191]
    ds_read_b128 v[212:215], v23 offset:40960
    s_waitcnt lgkmcnt(10)
    v_mfma_f32_32x32x16_bf16 v[96:111], v[228:231], v[200:203], v[96:111]
    ds_read_b64_tr_b16 v[228:229], v31 offset:28672
    ds_read_b64_tr_b16 v[230:231], v31 offset:30720
    s_waitcnt lgkmcnt(11)
    v_mfma_f32_32x32x16_bf16 v[176:191], v[216:219], v[56:59], v[176:191]
    ds_read_b128 v[216:219], v24 offset:40960
    s_waitcnt lgkmcnt(10)
    v_mfma_f32_32x32x16_bf16 v[112:127], v[232:235], v[200:203], v[112:127]
    ds_read_b64_tr_b16 v[232:233], v32 offset:28672
    ds_read_b64_tr_b16 v[234:235], v32 offset:30720
    s_waitcnt lgkmcnt(11)
    v_mfma_f32_32x32x16_bf16 v[176:191], v[220:223], v[60:63], v[176:191]
    ds_read_b128 v[220:223], v25 offset:40960
    s_waitcnt lgkmcnt(10)
    v_mfma_f32_32x32x16_bf16 v[128:143], v[236:239], v[200:203], v[128:143]
    ds_read_b64_tr_b16 v[236:237], v33 offset:28672
    ds_read_b64_tr_b16 v[238:239], v33 offset:30720
    s_waitcnt lgkmcnt(11)
    v_mfma_f32_32x32x16_bf16 v[176:191], v[208:211], v[64:67], v[176:191]
    s_waitcnt lgkmcnt(9)
    v_mfma_f32_32x32x16_bf16 v[80:95], v[224:227], v[204:207], v[80:95]
    s_waitcnt lgkmcnt(8)
    v_mfma_f32_32x32x16_bf16 v[176:191], v[212:215], v[68:71], v[176:191]
    s_waitcnt lgkmcnt(6)
    v_mfma_f32_32x32x16_bf16 v[96:111], v[228:231], v[204:207], v[96:111]
    s_waitcnt lgkmcnt(5)
    v_mfma_f32_32x32x16_bf16 v[176:191], v[216:219], v[72:75], v[176:191]
    s_waitcnt lgkmcnt(3)
    v_mfma_f32_32x32x16_bf16 v[112:127], v[232:235], v[204:207], v[112:127]
    s_waitcnt lgkmcnt(2)
    v_mfma_f32_32x32x16_bf16 v[176:191], v[220:223], v[76:79], v[176:191]
    s_waitcnt lgkmcnt(0)
    v_mfma_f32_32x32x16_bf16 v[128:143], v[236:239], v[204:207], v[128:143]
    s_setprio 0
    s_waitcnt vmcnt(4)
    s_barrier
    s_add_u32 m0, s25, 65536
    s_nop 0
    buffer_load_dwordx4 v34, s[4:7], s26 offen lds
    s_add_u32 m0, s25, 66560
    s_nop 0
    buffer_load_dwordx4 v35, s[4:7], s26 offen lds
    s_add_u32 m0, s25, 49152
    s_nop 0
    buffer_load_dwordx4 v36, s[8:11], s42 offen lds
    buffer_load_dwordx4 v36, s[8:11], s42 offen offset:1024 lds
    s_add_u32 s26, s26, 16384
    s_add_u32 s42, s42, 16384
    v_max3_f32 v38, v160, v161, v162
    v_max3_f32 v38, v38, v163, v164
    v_max3_f32 v38, v38, v165, v166
    v_max3_f32 v38, v38, v167, v168
    v_max3_f32 v38, v38, v169, v170
    v_max3_f32 v38, v38, v171, v172
    v_max3_f32 v38, v38, v173, v174
    v_max3_f32 v38, v38, v175, v176
    v_max3_f32 v38, v38, v177, v178
    v_max3_f32 v38, v38, v179, v180
    v_max3_f32 v38, v38, v181, v182
    v_max3_f32 v38, v38, v183, v184
    v_max3_f32 v38, v38, v185, v186
    v_max3_f32 v38, v38, v187, v188
    v_max3_f32 v38, v38, v189, v190
    v_max_f32 v38, v38, v191
    v_cmp_lt_f32 vcc, s28, v38
    s_nop 4
    s_cbranch_vccz K1_nr_p3
    v_mov_b32 v6, v38
    v_mov_b32 v7, v38
    s_nop 0
    s_nop 0
    v_permlane32_swap_b32 v6, v7
    v_max_f32 v41, v6, v7
    v_max_f32 v41, s29, v41
    v_sub_f32 v42, 0, v41
    v_min_f32 v42, 0x42c80000, v42
    v_exp_f32 v42, v42
    v_sub_f32 v160, v160, v41
    v_sub_f32 v161, v161, v41
    v_sub_f32 v162, v162, v41
    v_sub_f32 v163, v163, v41
    v_sub_f32 v164, v164, v41
    v_sub_f32 v165, v165, v41
    v_sub_f32 v166, v166, v41
    v_sub_f32 v167, v167, v41
    v_sub_f32 v168, v168, v41
    v_sub_f32 v169, v169, v41
    v_sub_f32 v170, v170, v41
    v_sub_f32 v171, v171, v41
    v_sub_f32 v172, v172, v41
    v_sub_f32 v173, v173, v41
    v_sub_f32 v174, v174, v41
    v_sub_f32 v175, v175, v41
    v_sub_f32 v176, v176, v41
    v_sub_f32 v177, v177, v41
    v_sub_f32 v178, v178, v41
    v_sub_f32 v179, v179, v41
    v_sub_f32 v180, v180, v41
    v_sub_f32 v181, v181, v41
    v_sub_f32 v182, v182, v41
    v_sub_f32 v183, v183, v41
    v_sub_f32 v184, v184, v41
    v_sub_f32 v185, v185, v41
    v_sub_f32 v186, v186, v41
    v_sub_f32 v187, v187, v41
    v_sub_f32 v188, v188, v41
    v_sub_f32 v189, v189, v41
    v_sub_f32 v190, v190, v41
    v_sub_f32 v191, v191, v41
    v_sub_f32 v144, v144, v41
    v_sub_f32 v145, v145, v41
    v_sub_f32 v146, v146, v41
    v_sub_f32 v147, v147, v41
    v_sub_f32 v148, v148, v41
    v_sub_f32 v149, v149, v41
    v_sub_f32 v150, v150, v41
    v_sub_f32 v151, v151, v41
    v_sub_f32 v152, v152, v41
    v_sub_f32 v153, v153, v41
    v_sub_f32 v154, v154, v41
    v_sub_f32 v155, v155, v41
    v_sub_f32 v156, v156, v41
    v_sub_f32 v157, v157, v41
    v_sub_f32 v158, v158, v41
    v_sub_f32 v159, v159, v41
    v_mul_f32 v37, v37, v42
    v_mul_f32 v39, v39, v42
    v_mul_f32 v80, v80, v42
    v_mul_f32 v81, v81, v42
    v_mul_f32 v82, v82, v42
    v_mul_f32 v83, v83, v42
    v_mul_f32 v84, v84, v42
    v_mul_f32 v85, v85, v42
    v_mul_f32 v86, v86, v42
    v_mul_f32 v87, v87, v42
    v_mul_f32 v88, v88, v42
    v_mul_f32 v89, v89, v42
    v_mul_f32 v90, v90, v42
    v_mul_f32 v91, v91, v42
    v_mul_f32 v92, v92, v42
    v_mul_f32 v93, v93, v42
    v_mul_f32 v94, v94, v42
    v_mul_f32 v95, v95, v42
    v_mul_f32 v96, v96, v42
    v_mul_f32 v97, v97, v42
    v_mul_f32 v98, v98, v42
    v_mul_f32 v99, v99, v42
    v_mul_f32 v100, v100, v42
    v_mul_f32 v101, v101, v42
    v_mul_f32 v102, v102, v42
    v_mul_f32 v103, v103, v42
    v_mul_f32 v104, v104, v42
    v_mul_f32 v105, v105, v42
    v_mul_f32 v106, v106, v42
    v_mul_f32 v107, v107, v42
    v_mul_f32 v108, v108, v42
    v_mul_f32 v109, v109, v42
    v_mul_f32 v110, v110, v42
    v_mul_f32 v111, v111, v42
    v_mul_f32 v112, v112, v42
    v_mul_f32 v113, v113, v42
    v_mul_f32 v114, v114, v42
    v_mul_f32 v115, v115, v42
    v_mul_f32 v116, v116, v42
    v_mul_f32 v117, v117, v42
    v_mul_f32 v118, v118, v42
    v_mul_f32 v119, v119, v42
    v_mul_f32 v120, v120, v42
    v_mul_f32 v121, v121, v42
    v_mul_f32 v122, v122, v42
    v_mul_f32 v123, v123, v42
    v_mul_f32 v124, v124, v42
    v_mul_f32 v125, v125, v42
    v_mul_f32 v126, v126, v42
    v_mul_f32 v127, v127, v42
    v_mul_f32 v128, v128, v42
    v_mul_f32 v129, v129, v42
    v_mul_f32 v130, v130, v42
    v_mul_f32 v131, v131, v42
    v_mul_f32 v132, v132, v42
    v_mul_f32 v133, v133, v42
    v_mul_f32 v134, v134, v42
    v_mul_f32 v135, v135, v42
    v_mul_f32 v136, v136, v42
    v_mul_f32 v137, v137, v42
    v_mul_f32 v138, v138, v42
    v_mul_f32 v139, v139, v42
    v_mul_f32 v140, v140, v42
    v_mul_f32 v141, v141, v42
    v_mul_f32 v142, v142, v42
    v_mul_f32 v143, v143, v42
    s_nop 15
K1_nr_p3:
    s_mov_b32 s28, 0x41000000
    s_mov_b32 s29, 0
    v_exp_f32 v160, v160
    v_exp_f32 v161, v161
    v_exp_f32 v162, v162
    v_exp_f32 v163, v163
    v_add_f32 v37, v37, v160
    v_add_f32 v39, v39, v161
    v_cvt_pk_bf16_f32 v192, v160, v161
    v_exp_f32 v164, v164
    v_exp_f32 v165, v165
    v_add_f32 v37, v37, v162
    v_add_f32 v39, v39, v163
    v_cvt_pk_bf16_f32 v193, v162, v163
    v_exp_f32 v166, v166
    v_exp_f32 v167, v167
    v_add_f32 v37, v37, v164
    v_add_f32 v39, v39, v165
    v_cvt_pk_bf16_f32 v194, v164, v165
    v_exp_f32 v168, v168
    v_exp_f32 v169, v169
    v_add_f32 v37, v37, v166
    v_add_f32 v39, v39, v167
    v_cvt_pk_bf16_f32 v195, v166, v167
    v_exp_f32 v170, v170
    v_exp_f32 v171, v171
    v_add_f32 v37, v37, v168
    v_add_f32 v39, v39, v169
    v_cvt_pk_bf16_f32 v196, v168, v169
    v_exp_f32 v172, v172
    v_exp_f32 v173, v173
    v_add_f32 v37, v37, v170
    v_add_f32 v39, v39, v171
    v_cvt_pk_bf16_f32 v197, v170, v171
    v_exp_f32 v174, v174
    v_exp_f32 v175, v175
    v_add_f32 v37, v37, v172
    v_add_f32 v39, v39, v173
    v_cvt_pk_bf16_f32 v198, v172, v173
    v_exp_f32 v176, v176
    v_exp_f32 v177, v177
    v_add_f32 v37, v37, v174
    v_add_f32 v39, v39, v175
    v_cvt_pk_bf16_f32 v199, v174, v175
    v_exp_f32 v178, v178
    v_exp_f32 v179, v179
    v_add_f32 v37, v37, v176
    v_add_f32 v39, v39, v177
    v_cvt_pk_bf16_f32 v200, v176, v177
    v_exp_f32 v180, v180
    v_exp_f32 v181, v181
    v_add_f32 v37, v37, v178
    v_add_f32 v39, v39, v179
    v_cvt_pk_bf16_f32 v201, v178, v179
    v_exp_f32 v182, v182
    v_exp_f32 v183, v183
    v_add_f32 v37, v37, v180
    v_add_f32 v39, v39, v181
    v_cvt_pk_bf16_f32 v202, v180, v181
    v_exp_f32 v184, v184
    v_exp_f32 v185, v185
    v_add_f32 v37, v37, v182
    v_add_f32 v39, v39, v183
    v_cvt_pk_bf16_f32 v203, v182, v183
    v_exp_f32 v186, v186
    v_exp_f32 v187, v187
    v_add_f32 v37, v37, v184
    v_add_f32 v39, v39, v185
    v_cvt_pk_bf16_f32 v204, v184, v185
    v_exp_f32 v188, v188
    v_exp_f32 v189, v189
    v_add_f32 v37, v37, v186
    v_add_f32 v39, v39, v187
    v_cvt_pk_bf16_f32 v205, v186, v187
    v_exp_f32 v190, v190
    v_exp_f32 v191, v191
    v_add_f32 v37, v37, v188
    v_add_f32 v39, v39, v189
    v_cvt_pk_bf16_f32 v206, v188, v189
    v_add_f32 v37, v37, v190
    v_add_f32 v39, v39, v191
    v_cvt_pk_bf16_f32 v207, v190, v191
    ds_read_b64_tr_b16 v[224:225], v30 offset:49152
    ds_read_b64_tr_b16 v[226:227], v30 offset:51200
    ds_read_b64_tr_b16 v[228:229], v31 offset:49152
    ds_read_b64_tr_b16 v[230:231], v31 offset:51200
    ds_read_b64_tr_b16 v[232:233], v32 offset:49152
    ds_read_b64_tr_b16 v[234:235], v32 offset:51200
    ds_read_b64_tr_b16 v[236:237], v33 offset:49152
    ds_read_b64_tr_b16 v[238:239], v33 offset:51200
    s_waitcnt vmcnt(4)
    s_barrier
    s_setprio 1
    s_waitcnt lgkmcnt(6)
    v_mfma_f32_32x32x16_bf16 v[80:95], v[224:227], v[192:195], v[80:95]
    ds_read_b64_tr_b16 v[224:225], v30 offset:53248
    ds_read_b64_tr_b16 v[226:227], v30 offset:55296
    s_waitcnt lgkmcnt(6)
    v_mfma_f32_32x32x16_bf16 v[96:111], v[228:231], v[192:195], v[96:111]
    ds_read_b64_tr_b16 v[228:229], v31 offset:53248
    ds_read_b64_tr_b16 v[230:231], v31 offset:55296
    s_waitcnt lgkmcnt(6)
    v_mfma_f32_32x32x16_bf16 v[112:127], v[232:235], v[192:195], v[112:127]
    ds_read_b64_tr_b16 v[232:233], v32 offset:53248
    ds_read_b64_tr_b16 v[234:235], v32 offset:55296
    s_waitcnt lgkmcnt(6)
    v_mfma_f32_32x32x16_bf16 v[128:143], v[236:239], v[192:195], v[128:143]
    ds_read_b64_tr_b16 v[236:237], v33 offset:53248
    ds_read_b64_tr_b16 v[238:239], v33 offset:55296
    s_waitcnt lgkmcnt(6)
    v_mfma_f32_32x32x16_bf16 v[80:95], v[224:227], v[196:199], v[80:95]
    ds_read_b64_tr_b16 v[224:225], v30 offset:57344
    ds_read_b64_tr_b16 v[226:227], v30 offset:59392
    s_waitcnt lgkmcnt(6)
    v_mfma_f32_32x32x16_bf16 v[96:111], v[228:231], v[196:199], v[96:111]
    ds_read_b64_tr_b16 v[228:229], v31 offset:57344
    ds_read_b64_tr_b16 v[230:231], v31 offset:59392
    s_waitcnt lgkmcnt(6)
    v_mfma_f32_32x32x16_bf16 v[112:127], v[232:235], v[196:199], v[112:127]
    ds_read_b64_tr_b16 v[232:233], v32 offset:57344
    ds_read_b64_tr_b16 v[234:235], v32 offset:59392
    s_waitcnt lgkmcnt(6)
    v_mfma_f32_32x32x16_bf16 v[128:143], v[236:239], v[196:199], v[128:143]
    ds_read_b64_tr_b16 v[236:237], v33 offset:57344
    ds_read_b64_tr_b16 v[238:239], v33 offset:59392
    s_waitcnt lgkmcnt(6)
    v_mfma_f32_32x32x16_bf16 v[80:95], v[224:227], v[200:203], v[80:95]
    ds_read_b64_tr_b16 v[224:225], v30 offset:61440
    ds_read_b64_tr_b16 v[226:227], v30 offset:63488
    s_waitcnt lgkmcnt(6)
    v_mfma_f32_32x32x16_bf16 v[96:111], v[228:231], v[200:203], v[96:111]
    ds_read_b64_tr_b16 v[228:229], v31 offset:61440
    ds_read_b64_tr_b16 v[230:231], v31 offset:63488
    s_waitcnt lgkmcnt(6)
    v_mfma_f32_32x32x16_bf16 v[112:127], v[232:235], v[200:203], v[112:127]
    ds_read_b64_tr_b16 v[232:233], v32 offset:61440
    ds_read_b64_tr_b16 v[234:235], v32 offset:63488
    s_waitcnt lgkmcnt(6)
    v_mfma_f32_32x32x16_bf16 v[128:143], v[236:239], v[200:203], v[128:143]
    ds_read_b64_tr_b16 v[236:237], v33 offset:61440
    ds_read_b64_tr_b16 v[238:239], v33 offset:63488
    s_waitcnt lgkmcnt(6)
    v_mfma_f32_32x32x16_bf16 v[80:95], v[224:227], v[204:207], v[80:95]
    s_waitcnt lgkmcnt(4)
    v_mfma_f32_32x32x16_bf16 v[96:111], v[228:231], v[204:207], v[96:111]
    s_waitcnt lgkmcnt(2)
    v_mfma_f32_32x32x16_bf16 v[112:127], v[232:235], v[204:207], v[112:127]
    s_waitcnt lgkmcnt(0)
    v_mfma_f32_32x32x16_bf16 v[128:143], v[236:239], v[204:207], v[128:143]
    s_setprio 0
    s_cmp_ge_u32 s24, 4
    s_cbranch_scc1 K1_h1
    s_barrier
K1_h1:
    s_nop 15
    v_add_f32 v37, v37, v39
    v_mov_b32 v6, v37
    v_mov_b32 v7, v37
    s_nop 0
    s_nop 0
    v_permlane32_swap_b32 v6, v7
    v_add_f32 v6, v6, v7
    v_rcp_f32 v6, v6
    s_nop 0
    v_mul_f32 v80, v80, v6
    v_mul_f32 v81, v81, v6
    v_mul_f32 v82, v82, v6
    v_mul_f32 v83, v83, v6
    v_mul_f32 v84, v84, v6
    v_mul_f32 v85, v85, v6
    v_mul_f32 v86, v86, v6
    v_mul_f32 v87, v87, v6
    v_mul_f32 v88, v88, v6
    v_mul_f32 v89, v89, v6
    v_mul_f32 v90, v90, v6
    v_mul_f32 v91, v91, v6
    v_mul_f32 v92, v92, v6
    v_mul_f32 v93, v93, v6
    v_mul_f32 v94, v94, v6
    v_mul_f32 v95, v95, v6
    v_mul_f32 v96, v96, v6
    v_mul_f32 v97, v97, v6
    v_mul_f32 v98, v98, v6
    v_mul_f32 v99, v99, v6
    v_mul_f32 v100, v100, v6
    v_mul_f32 v101, v101, v6
    v_mul_f32 v102, v102, v6
    v_mul_f32 v103, v103, v6
    v_mul_f32 v104, v104, v6
    v_mul_f32 v105, v105, v6
    v_mul_f32 v106, v106, v6
    v_mul_f32 v107, v107, v6
    v_mul_f32 v108, v108, v6
    v_mul_f32 v109, v109, v6
    v_mul_f32 v110, v110, v6
    v_mul_f32 v111, v111, v6
    v_mul_f32 v112, v112, v6
    v_mul_f32 v113, v113, v6
    v_mul_f32 v114, v114, v6
    v_mul_f32 v115, v115, v6
    v_mul_f32 v116, v116, v6
    v_mul_f32 v117, v117, v6
    v_mul_f32 v118, v118, v6
    v_mul_f32 v119, v119, v6
    v_mul_f32 v120, v120, v6
    v_mul_f32 v121, v121, v6
    v_mul_f32 v122, v122, v6
    v_mul_f32 v123, v123, v6
    v_mul_f32 v124, v124, v6
    v_mul_f32 v125, v125, v6
    v_mul_f32 v126, v126, v6
    v_mul_f32 v127, v127, v6
    v_mul_f32 v128, v128, v6
    v_mul_f32 v129, v129, v6
    v_mul_f32 v130, v130, v6
    v_mul_f32 v131, v131, v6
    v_mul_f32 v132, v132, v6
    v_mul_f32 v133, v133, v6
    v_mul_f32 v134, v134, v6
    v_mul_f32 v135, v135, v6
    v_mul_f32 v136, v136, v6
    v_mul_f32 v137, v137, v6
    v_mul_f32 v138, v138, v6
    v_mul_f32 v139, v139, v6
    v_mul_f32 v140, v140, v6
    v_mul_f32 v141, v141, v6
    v_mul_f32 v142, v142, v6
    v_mul_f32 v143, v143, v6
    v_cvt_pk_bf16_f32 v160, v80, v81
    v_cvt_pk_bf16_f32 v161, v82, v83
    v_cvt_pk_bf16_f32 v162, v84, v85
    v_cvt_pk_bf16_f32 v163, v86, v87
    s_nop 0
    v_permlane32_swap_b32 v160, v162
    v_permlane32_swap_b32 v161, v163
    buffer_store_dwordx4 v[160:163], v44, s[20:23], 0 offen offset:0
    v_cvt_pk_bf16_f32 v164, v88, v89
    v_cvt_pk_bf16_f32 v165, v90, v91
    v_cvt_pk_bf16_f32 v166, v92, v93
    v_cvt_pk_bf16_f32 v167, v94, v95
    s_nop 0
    v_permlane32_swap_b32 v164, v166
    v_permlane32_swap_b32 v165, v167
    buffer_store_dwordx4 v[164:167], v44, s[20:23], 0 offen offset:1024
    v_cvt_pk_bf16_f32 v168, v96, v97
    v_cvt_pk_bf16_f32 v169, v98, v99
    v_cvt_pk_bf16_f32 v170, v100, v101
    v_cvt_pk_bf16_f32 v171, v102, v103
    s_nop 0
    v_permlane32_swap_b32 v168, v170
    v_permlane32_swap_b32 v169, v171
    buffer_store_dwordx4 v[168:171], v44, s[20:23], 0 offen offset:2048
    v_cvt_pk_bf16_f32 v172, v104, v105
    v_cvt_pk_bf16_f32 v173, v106, v107
    v_cvt_pk_bf16_f32 v174, v108, v109
    v_cvt_pk_bf16_f32 v175, v110, v111
    s_nop 0
    v_permlane32_swap_b32 v172, v174
    v_permlane32_swap_b32 v173, v175
    buffer_store_dwordx4 v[172:175], v44, s[20:23], 0 offen offset:3072
    v_add_u32 v44, 4096, v44
    v_cvt_pk_bf16_f32 v176, v112, v113
    v_cvt_pk_bf16_f32 v177, v114, v115
    v_cvt_pk_bf16_f32 v178, v116, v117
    v_cvt_pk_bf16_f32 v179, v118, v119
    s_nop 0
    v_permlane32_swap_b32 v176, v178
    v_permlane32_swap_b32 v177, v179
    buffer_store_dwordx4 v[176:179], v44, s[20:23], 0 offen offset:0
    v_cvt_pk_bf16_f32 v180, v120, v121
    v_cvt_pk_bf16_f32 v181, v122, v123
    v_cvt_pk_bf16_f32 v182, v124, v125
    v_cvt_pk_bf16_f32 v183, v126, v127
    s_nop 0
    v_permlane32_swap_b32 v180, v182
    v_permlane32_swap_b32 v181, v183
    buffer_store_dwordx4 v[180:183], v44, s[20:23], 0 offen offset:1024
    v_cvt_pk_bf16_f32 v184, v128, v129
    v_cvt_pk_bf16_f32 v185, v130, v131
    v_cvt_pk_bf16_f32 v186, v132, v133
    v_cvt_pk_bf16_f32 v187, v134, v135
    s_nop 0
    v_permlane32_swap_b32 v184, v186
    v_permlane32_swap_b32 v185, v187
    buffer_store_dwordx4 v[184:187], v44, s[20:23], 0 offen offset:2048
    v_cvt_pk_bf16_f32 v188, v136, v137
    v_cvt_pk_bf16_f32 v189, v138, v139
    v_cvt_pk_bf16_f32 v190, v140, v141
    v_cvt_pk_bf16_f32 v191, v142, v143
    s_nop 0
    v_permlane32_swap_b32 v188, v190
    v_permlane32_swap_b32 v189, v191
    buffer_store_dwordx4 v[188:191], v44, s[20:23], 0 offen offset:3072
    s_waitcnt vmcnt(0)
    s_endpgm
K1_done:
    s_endpgm
.text
.globl oproj_kernel
.p2align 8
.type oproj_kernel,@function
oproj_kernel:
    s_cmp_ge_u32 s2, 256
    s_cbranch_scc1 K2_done
    s_load_dwordx2 s[34:35], s[0:1], 40
    s_load_dwordx2 s[36:37], s[0:1], 56
    v_and_b32 v1, 63, v0
    v_lshrrev_b32 v6, 6, v0
    s_nop 0
    v_readfirstlane_b32 s16, v6
    v_and_b32 v2, 31, v1
    v_lshrrev_b32 v3, 5, v1
    s_and_b32 s26, s2, 31
    s_lshr_b32 s27, s2, 5
    s_lshl_b32 s20, s26, 19
    s_lshl_b32 s21, s16, 15
    s_add_u32 s20, s20, s21
    v_lshlrev_b32 v6, 4, v1
    v_add_u32 v10, s20, v6
    v_add_u32 v11, 0x40000, v10
    s_lshl_b32 s20, s27, 19
    s_add_u32 s20, s20, s21
    s_add_u32 s20, s20, 16777216
    v_add_u32 v8, s20, v6
    v_add_u32 v9, 0x40000, v8
    s_waitcnt lgkmcnt(0)
    s_mov_b32 s4, s36
    s_mov_b32 s5, s37
    s_mov_b32 s6, 20971520
    s_mov_b32 s7, 0x00020000
    s_mov_b32 s12, s34
    s_mov_b32 s13, s35
    s_mov_b32 s14, 2097152
    s_mov_b32 s15, 0x00020000
    s_mov_b32 s19, 0
    buffer_load_dwordx4 v[80:83], v8, s[4:7], s19 offen offset:0
    buffer_load_dwordx4 v[84:87], v10, s[4:7], s19 offen offset:0
    buffer_load_dwordx4 v[88:91], v9, s[4:7], s19 offen offset:0
    buffer_load_dwordx4 v[92:95], v11, s[4:7], s19 offen offset:0
    buffer_load_dwordx4 v[96:99], v8, s[4:7], s19 offen offset:1024
    buffer_load_dwordx4 v[100:103], v10, s[4:7], s19 offen offset:1024
    buffer_load_dwordx4 v[104:107], v9, s[4:7], s19 offen offset:1024
    buffer_load_dwordx4 v[108:111], v11, s[4:7], s19 offen offset:1024
    buffer_load_dwordx4 v[112:115], v8, s[4:7], s19 offen offset:2048
    buffer_load_dwordx4 v[116:119], v10, s[4:7], s19 offen offset:2048
    buffer_load_dwordx4 v[120:123], v9, s[4:7], s19 offen offset:2048
    buffer_load_dwordx4 v[124:127], v11, s[4:7], s19 offen offset:2048
    buffer_load_dwordx4 v[128:131], v8, s[4:7], s19 offen offset:3072
    buffer_load_dwordx4 v[132:135], v10, s[4:7], s19 offen offset:3072
    buffer_load_dwordx4 v[136:139], v9, s[4:7], s19 offen offset:3072
    buffer_load_dwordx4 v[140:143], v11, s[4:7], s19 offen offset:3072
    s_mov_b32 s19, 4096
    buffer_load_dwordx4 v[144:147], v8, s[4:7], s19 offen offset:0
    buffer_load_dwordx4 v[148:151], v10, s[4:7], s19 offen offset:0
    buffer_load_dwordx4 v[152:155], v9, s[4:7], s19 offen offset:0
    buffer_load_dwordx4 v[156:159], v11, s[4:7], s19 offen offset:0
    buffer_load_dwordx4 v[160:163], v8, s[4:7], s19 offen offset:1024
    buffer_load_dwordx4 v[164:167], v10, s[4:7], s19 offen offset:1024
    buffer_load_dwordx4 v[168:171], v9, s[4:7], s19 offen offset:1024
    buffer_load_dwordx4 v[172:175], v11, s[4:7], s19 offen offset:1024
    buffer_load_dwordx4 v[176:179], v8, s[4:7], s19 offen offset:2048
    buffer_load_dwordx4 v[180:183], v10, s[4:7], s19 offen offset:2048
    buffer_load_dwordx4 v[184:187], v9, s[4:7], s19 offen offset:2048
    buffer_load_dwordx4 v[188:191], v11, s[4:7], s19 offen offset:2048
    buffer_load_dwordx4 v[192:195], v8, s[4:7], s19 offen offset:3072
    buffer_load_dwordx4 v[196:199], v10, s[4:7], s19 offen offset:3072
    buffer_load_dwordx4 v[200:203], v9, s[4:7], s19 offen offset:3072
    buffer_load_dwordx4 v[204:207], v11, s[4:7], s19 offen offset:3072
    s_lshl_b32 s20, s16, 14
    v_add_u32 v13, s20, v6
    s_lshl_b32 s20, s16, 11
    v_add_u32 v14, s20, v6
    s_lshr_b32 s20, s16, 1
    s_and_b32 s20, s20, 1
    s_lshl_b32 s20, s20, 5
    s_lshl_b32 s21, s26, 6
    s_add_u32 s20, s20, s21
    v_add_u32 v7, s20, v2
    v_lshlrev_b32 v7, 10, v7
    v_lshl_add_u32 v12, v3, 4, v7
    s_lshr_b32 s20, s16, 2
    s_lshl_b32 s20, s20, 6
    s_lshl_b32 s21, s27, 7
    s_add_u32 s20, s20, s21
    s_and_b32 s21, s16, 1
    s_lshl_b32 s21, s21, 5
    s_add_u32 s20, s20, s21
    v_add_u32 v12, s20, v12
    v_mov_b32 v16, 0
    v_mov_b32 v17, 0
    v_mov_b32 v18, 0
    v_mov_b32 v19, 0
    v_mov_b32 v20, 0
    v_mov_b32 v21, 0
    v_mov_b32 v22, 0
    v_mov_b32 v23, 0
    v_mov_b32 v24, 0
    v_mov_b32 v25, 0
    v_mov_b32 v26, 0
    v_mov_b32 v27, 0
    v_mov_b32 v28, 0
    v_mov_b32 v29, 0
    v_mov_b32 v30, 0
    v_mov_b32 v31, 0
    v_mov_b32 v32, 0
    v_mov_b32 v33, 0
    v_mov_b32 v34, 0
    v_mov_b32 v35, 0
    v_mov_b32 v36, 0
    v_mov_b32 v37, 0
    v_mov_b32 v38, 0
    v_mov_b32 v39, 0
    v_mov_b32 v40, 0
    v_mov_b32 v41, 0
    v_mov_b32 v42, 0
    v_mov_b32 v43, 0
    v_mov_b32 v44, 0
    v_mov_b32 v45, 0
    v_mov_b32 v46, 0
    v_mov_b32 v47, 0
    v_mov_b32 v48, 0
    v_mov_b32 v49, 0
    v_mov_b32 v50, 0
    v_mov_b32 v51, 0
    v_mov_b32 v52, 0
    v_mov_b32 v53, 0
    v_mov_b32 v54, 0
    v_mov_b32 v55, 0
    v_mov_b32 v56, 0
    v_mov_b32 v57, 0
    v_mov_b32 v58, 0
    v_mov_b32 v59, 0
    v_mov_b32 v60, 0
    v_mov_b32 v61, 0
    v_mov_b32 v62, 0
    v_mov_b32 v63, 0
    v_mov_b32 v64, 0
    v_mov_b32 v65, 0
    v_mov_b32 v66, 0
    v_mov_b32 v67, 0
    v_mov_b32 v68, 0
    v_mov_b32 v69, 0
    v_mov_b32 v70, 0
    v_mov_b32 v71, 0
    v_mov_b32 v72, 0
    v_mov_b32 v73, 0
    v_mov_b32 v74, 0
    v_mov_b32 v75, 0
    v_mov_b32 v76, 0
    v_mov_b32 v77, 0
    v_mov_b32 v78, 0
    v_mov_b32 v79, 0
    s_waitcnt vmcnt(28)
    v_mfma_f32_32x32x16_bf16 v[16:31], v[80:83], v[84:87], v[16:31]
    v_mfma_f32_32x32x16_bf16 v[48:63], v[88:91], v[84:87], v[48:63]
    v_mfma_f32_32x32x16_bf16 v[32:47], v[80:83], v[92:95], v[32:47]
    v_mfma_f32_32x32x16_bf16 v[64:79], v[88:91], v[92:95], v[64:79]
    s_nop 1
    s_mov_b32 s19, 8192
    buffer_load_dwordx4 v[80:83], v8, s[4:7], s19 offen offset:0
    buffer_load_dwordx4 v[84:87], v10, s[4:7], s19 offen offset:0
    buffer_load_dwordx4 v[88:91], v9, s[4:7], s19 offen offset:0
    buffer_load_dwordx4 v[92:95], v11, s[4:7], s19 offen offset:0
    s_waitcnt vmcnt(28)
    v_mfma_f32_32x32x16_bf16 v[16:31], v[96:99], v[100:103], v[16:31]
    v_mfma_f32_32x32x16_bf16 v[48:63], v[104:107], v[100:103], v[48:63]
    v_mfma_f32_32x32x16_bf16 v[32:47], v[96:99], v[108:111], v[32:47]
    v_mfma_f32_32x32x16_bf16 v[64:79], v[104:107], v[108:111], v[64:79]
    s_nop 1
    buffer_load_dwordx4 v[96:99], v8, s[4:7], s19 offen offset:1024
    buffer_load_dwordx4 v[100:103], v10, s[4:7], s19 offen offset:1024
    buffer_load_dwordx4 v[104:107], v9, s[4:7], s19 offen offset:1024
    buffer_load_dwordx4 v[108:111], v11, s[4:7], s19 offen offset:1024
    s_waitcnt vmcnt(28)
    v_mfma_f32_32x32x16_bf16 v[16:31], v[112:115], v[116:119], v[16:31]
    v_mfma_f32_32x32x16_bf16 v[48:63], v[120:123], v[116:119], v[48:63]
    v_mfma_f32_32x32x16_bf16 v[32:47], v[112:115], v[124:127], v[32:47]
    v_mfma_f32_32x32x16_bf16 v[64:79], v[120:123], v[124:127], v[64:79]
    s_nop 1
    buffer_load_dwordx4 v[112:115], v8, s[4:7], s19 offen offset:2048
    buffer_load_dwordx4 v[116:119], v10, s[4:7], s19 offen offset:2048
    buffer_load_dwordx4 v[120:123], v9, s[4:7], s19 offen offset:2048
    buffer_load_dwordx4 v[124:127], v11, s[4:7], s19 offen offset:2048
    s_waitcnt vmcnt(28)
    v_mfma_f32_32x32x16_bf16 v[16:31], v[128:131], v[132:135], v[16:31]
    v_mfma_f32_32x32x16_bf16 v[48:63], v[136:139], v[132:135], v[48:63]
    v_mfma_f32_32x32x16_bf16 v[32:47], v[128:131], v[140:143], v[32:47]
    v_mfma_f32_32x32x16_bf16 v[64:79], v[136:139], v[140:143], v[64:79]
    s_nop 1
    buffer_load_dwordx4 v[128:131], v8, s[4:7], s19 offen offset:3072
    buffer_load_dwordx4 v[132:135], v10, s[4:7], s19 offen offset:3072
    buffer_load_dwordx4 v[136:139], v9, s[4:7], s19 offen offset:3072
    buffer_load_dwordx4 v[140:143], v11, s[4:7], s19 offen offset:3072
    s_waitcnt vmcnt(28)
    v_mfma_f32_32x32x16_bf16 v[16:31], v[144:147], v[148:151], v[16:31]
    v_mfma_f32_32x32x16_bf16 v[48:63], v[152:155], v[148:151], v[48:63]
    v_mfma_f32_32x32x16_bf16 v[32:47], v[144:147], v[156:159], v[32:47]
    v_mfma_f32_32x32x16_bf16 v[64:79], v[152:155], v[156:159], v[64:79]
    s_nop 1
    s_mov_b32 s19, 12288
    buffer_load_dwordx4 v[144:147], v8, s[4:7], s19 offen offset:0
    buffer_load_dwordx4 v[148:151], v10, s[4:7], s19 offen offset:0
    buffer_load_dwordx4 v[152:155], v9, s[4:7], s19 offen offset:0
    buffer_load_dwordx4 v[156:159], v11, s[4:7], s19 offen offset:0
    s_waitcnt vmcnt(28)
    v_mfma_f32_32x32x16_bf16 v[16:31], v[160:163], v[164:167], v[16:31]
    v_mfma_f32_32x32x16_bf16 v[48:63], v[168:171], v[164:167], v[48:63]
    v_mfma_f32_32x32x16_bf16 v[32:47], v[160:163], v[172:175], v[32:47]
    v_mfma_f32_32x32x16_bf16 v[64:79], v[168:171], v[172:175], v[64:79]
    s_nop 1
    buffer_load_dwordx4 v[160:163], v8, s[4:7], s19 offen offset:1024
    buffer_load_dwordx4 v[164:167], v10, s[4:7], s19 offen offset:1024
    buffer_load_dwordx4 v[168:171], v9, s[4:7], s19 offen offset:1024
    buffer_load_dwordx4 v[172:175], v11, s[4:7], s19 offen offset:1024
    s_waitcnt vmcnt(28)
    v_mfma_f32_32x32x16_bf16 v[16:31], v[176:179], v[180:183], v[16:31]
    v_mfma_f32_32x32x16_bf16 v[48:63], v[184:187], v[180:183], v[48:63]
    v_mfma_f32_32x32x16_bf16 v[32:47], v[176:179], v[188:191], v[32:47]
    v_mfma_f32_32x32x16_bf16 v[64:79], v[184:187], v[188:191], v[64:79]
    s_nop 1
    buffer_load_dwordx4 v[176:179], v8, s[4:7], s19 offen offset:2048
    buffer_load_dwordx4 v[180:183], v10, s[4:7], s19 offen offset:2048
    buffer_load_dwordx4 v[184:187], v9, s[4:7], s19 offen offset:2048
    buffer_load_dwordx4 v[188:191], v11, s[4:7], s19 offen offset:2048
    s_waitcnt vmcnt(28)
    v_mfma_f32_32x32x16_bf16 v[16:31], v[192:195], v[196:199], v[16:31]
    v_mfma_f32_32x32x16_bf16 v[48:63], v[200:203], v[196:199], v[48:63]
    v_mfma_f32_32x32x16_bf16 v[32:47], v[192:195], v[204:207], v[32:47]
    v_mfma_f32_32x32x16_bf16 v[64:79], v[200:203], v[204:207], v[64:79]
    s_nop 1
    buffer_load_dwordx4 v[192:195], v8, s[4:7], s19 offen offset:3072
    buffer_load_dwordx4 v[196:199], v10, s[4:7], s19 offen offset:3072
    buffer_load_dwordx4 v[200:203], v9, s[4:7], s19 offen offset:3072
    buffer_load_dwordx4 v[204:207], v11, s[4:7], s19 offen offset:3072
    s_waitcnt vmcnt(28)
    v_mfma_f32_32x32x16_bf16 v[16:31], v[80:83], v[84:87], v[16:31]
    v_mfma_f32_32x32x16_bf16 v[48:63], v[88:91], v[84:87], v[48:63]
    v_mfma_f32_32x32x16_bf16 v[32:47], v[80:83], v[92:95], v[32:47]
    v_mfma_f32_32x32x16_bf16 v[64:79], v[88:91], v[92:95], v[64:79]
    s_nop 1
    s_mov_b32 s19, 16384
    buffer_load_dwordx4 v[80:83], v8, s[4:7], s19 offen offset:0
    buffer_load_dwordx4 v[84:87], v10, s[4:7], s19 offen offset:0
    buffer_load_dwordx4 v[88:91], v9, s[4:7], s19 offen offset:0
    buffer_load_dwordx4 v[92:95], v11, s[4:7], s19 offen offset:0
    s_waitcnt vmcnt(28)
    v_mfma_f32_32x32x16_bf16 v[16:31], v[96:99], v[100:103], v[16:31]
    v_mfma_f32_32x32x16_bf16 v[48:63], v[104:107], v[100:103], v[48:63]
    v_mfma_f32_32x32x16_bf16 v[32:47], v[96:99], v[108:111], v[32:47]
    v_mfma_f32_32x32x16_bf16 v[64:79], v[104:107], v[108:111], v[64:79]
    s_nop 1
    buffer_load_dwordx4 v[96:99], v8, s[4:7], s19 offen offset:1024
    buffer_load_dwordx4 v[100:103], v10, s[4:7], s19 offen offset:1024
    buffer_load_dwordx4 v[104:107], v9, s[4:7], s19 offen offset:1024
    buffer_load_dwordx4 v[108:111], v11, s[4:7], s19 offen offset:1024
    s_waitcnt vmcnt(28)
    v_mfma_f32_32x32x16_bf16 v[16:31], v[112:115], v[116:119], v[16:31]
    v_mfma_f32_32x32x16_bf16 v[48:63], v[120:123], v[116:119], v[48:63]
    v_mfma_f32_32x32x16_bf16 v[32:47], v[112:115], v[124:127], v[32:47]
    v_mfma_f32_32x32x16_bf16 v[64:79], v[120:123], v[124:127], v[64:79]
    s_nop 1
    buffer_load_dwordx4 v[112:115], v8, s[4:7], s19 offen offset:2048
    buffer_load_dwordx4 v[116:119], v10, s[4:7], s19 offen offset:2048
    buffer_load_dwordx4 v[120:123], v9, s[4:7], s19 offen offset:2048
    buffer_load_dwordx4 v[124:127], v11, s[4:7], s19 offen offset:2048
    s_waitcnt vmcnt(28)
    v_mfma_f32_32x32x16_bf16 v[16:31], v[128:131], v[132:135], v[16:31]
    v_mfma_f32_32x32x16_bf16 v[48:63], v[136:139], v[132:135], v[48:63]
    v_mfma_f32_32x32x16_bf16 v[32:47], v[128:131], v[140:143], v[32:47]
    v_mfma_f32_32x32x16_bf16 v[64:79], v[136:139], v[140:143], v[64:79]
    s_nop 1
    buffer_load_dwordx4 v[128:131], v8, s[4:7], s19 offen offset:3072
    buffer_load_dwordx4 v[132:135], v10, s[4:7], s19 offen offset:3072
    buffer_load_dwordx4 v[136:139], v9, s[4:7], s19 offen offset:3072
    buffer_load_dwordx4 v[140:143], v11, s[4:7], s19 offen offset:3072
    s_waitcnt vmcnt(28)
    v_mfma_f32_32x32x16_bf16 v[16:31], v[144:147], v[148:151], v[16:31]
    v_mfma_f32_32x32x16_bf16 v[48:63], v[152:155], v[148:151], v[48:63]
    v_mfma_f32_32x32x16_bf16 v[32:47], v[144:147], v[156:159], v[32:47]
    v_mfma_f32_32x32x16_bf16 v[64:79], v[152:155], v[156:159], v[64:79]
    s_nop 1
    s_mov_b32 s19, 20480
    buffer_load_dwordx4 v[144:147], v8, s[4:7], s19 offen offset:0
    buffer_load_dwordx4 v[148:151], v10, s[4:7], s19 offen offset:0
    buffer_load_dwordx4 v[152:155], v9, s[4:7], s19 offen offset:0
    buffer_load_dwordx4 v[156:159], v11, s[4:7], s19 offen offset:0
    s_waitcnt vmcnt(28)
    v_mfma_f32_32x32x16_bf16 v[16:31], v[160:163], v[164:167], v[16:31]
    v_mfma_f32_32x32x16_bf16 v[48:63], v[168:171], v[164:167], v[48:63]
    v_mfma_f32_32x32x16_bf16 v[32:47], v[160:163], v[172:175], v[32:47]
    v_mfma_f32_32x32x16_bf16 v[64:79], v[168:171], v[172:175], v[64:79]
    s_nop 1
    buffer_load_dwordx4 v[160:163], v8, s[4:7], s19 offen offset:1024
    buffer_load_dwordx4 v[164:167], v10, s[4:7], s19 offen offset:1024
    buffer_load_dwordx4 v[168:171], v9, s[4:7], s19 offen offset:1024
    buffer_load_dwordx4 v[172:175], v11, s[4:7], s19 offen offset:1024
    s_waitcnt vmcnt(28)
    v_mfma_f32_32x32x16_bf16 v[16:31], v[176:179], v[180:183], v[16:31]
    v_mfma_f32_32x32x16_bf16 v[48:63], v[184:187], v[180:183], v[48:63]
    v_mfma_f32_32x32x16_bf16 v[32:47], v[176:179], v[188:191], v[32:47]
    v_mfma_f32_32x32x16_bf16 v[64:79], v[184:187], v[188:191], v[64:79]
    s_nop 1
    buffer_load_dwordx4 v[176:179], v8, s[4:7], s19 offen offset:2048
    buffer_load_dwordx4 v[180:183], v10, s[4:7], s19 offen offset:2048
    buffer_load_dwordx4 v[184:187], v9, s[4:7], s19 offen offset:2048
    buffer_load_dwordx4 v[188:191], v11, s[4:7], s19 offen offset:2048
    s_waitcnt vmcnt(28)
    v_mfma_f32_32x32x16_bf16 v[16:31], v[192:195], v[196:199], v[16:31]
    v_mfma_f32_32x32x16_bf16 v[48:63], v[200:203], v[196:199], v[48:63]
    v_mfma_f32_32x32x16_bf16 v[32:47], v[192:195], v[204:207], v[32:47]
    v_mfma_f32_32x32x16_bf16 v[64:79], v[200:203], v[204:207], v[64:79]
    s_nop 1
    buffer_load_dwordx4 v[192:195], v8, s[4:7], s19 offen offset:3072
    buffer_load_dwordx4 v[196:199], v10, s[4:7], s19 offen offset:3072
    buffer_load_dwordx4 v[200:203], v9, s[4:7], s19 offen offset:3072
    buffer_load_dwordx4 v[204:207], v11, s[4:7], s19 offen offset:3072
    s_waitcnt vmcnt(28)
    v_mfma_f32_32x32x16_bf16 v[16:31], v[80:83], v[84:87], v[16:31]
    v_mfma_f32_32x32x16_bf16 v[48:63], v[88:91], v[84:87], v[48:63]
    v_mfma_f32_32x32x16_bf16 v[32:47], v[80:83], v[92:95], v[32:47]
    v_mfma_f32_32x32x16_bf16 v[64:79], v[88:91], v[92:95], v[64:79]
    s_nop 1
    s_mov_b32 s19, 24576
    buffer_load_dwordx4 v[80:83], v8, s[4:7], s19 offen offset:0
    buffer_load_dwordx4 v[84:87], v10, s[4:7], s19 offen offset:0
    buffer_load_dwordx4 v[88:91], v9, s[4:7], s19 offen offset:0
    buffer_load_dwordx4 v[92:95], v11, s[4:7], s19 offen offset:0
    s_waitcnt vmcnt(28)
    v_mfma_f32_32x32x16_bf16 v[16:31], v[96:99], v[100:103], v[16:31]
    v_mfma_f32_32x32x16_bf16 v[48:63], v[104:107], v[100:103], v[48:63]
    v_mfma_f32_32x32x16_bf16 v[32:47], v[96:99], v[108:111], v[32:47]
    v_mfma_f32_32x32x16_bf16 v[64:79], v[104:107], v[108:111], v[64:79]
    s_nop 1
    buffer_load_dwordx4 v[96:99], v8, s[4:7], s19 offen offset:1024
    buffer_load_dwordx4 v[100:103], v10, s[4:7], s19 offen offset:1024
    buffer_load_dwordx4 v[104:107], v9, s[4:7], s19 offen offset:1024
    buffer_load_dwordx4 v[108:111], v11, s[4:7], s19 offen offset:1024
    s_waitcnt vmcnt(28)
    v_mfma_f32_32x32x16_bf16 v[16:31], v[112:115], v[116:119], v[16:31]
    v_mfma_f32_32x32x16_bf16 v[48:63], v[120:123], v[116:119], v[48:63]
    v_mfma_f32_32x32x16_bf16 v[32:47], v[112:115], v[124:127], v[32:47]
    v_mfma_f32_32x32x16_bf16 v[64:79], v[120:123], v[124:127], v[64:79]
    s_nop 1
    buffer_load_dwordx4 v[112:115], v8, s[4:7], s19 offen offset:2048
    buffer_load_dwordx4 v[116:119], v10, s[4:7], s19 offen offset:2048
    buffer_load_dwordx4 v[120:123], v9, s[4:7], s19 offen offset:2048
    buffer_load_dwordx4 v[124:127], v11, s[4:7], s19 offen offset:2048
    s_waitcnt vmcnt(28)
    v_mfma_f32_32x32x16_bf16 v[16:31], v[128:131], v[132:135], v[16:31]
    v_mfma_f32_32x32x16_bf16 v[48:63], v[136:139], v[132:135], v[48:63]
    v_mfma_f32_32x32x16_bf16 v[32:47], v[128:131], v[140:143], v[32:47]
    v_mfma_f32_32x32x16_bf16 v[64:79], v[136:139], v[140:143], v[64:79]
    s_nop 1
    buffer_load_dwordx4 v[128:131], v8, s[4:7], s19 offen offset:3072
    buffer_load_dwordx4 v[132:135], v10, s[4:7], s19 offen offset:3072
    buffer_load_dwordx4 v[136:139], v9, s[4:7], s19 offen offset:3072
    buffer_load_dwordx4 v[140:143], v11, s[4:7], s19 offen offset:3072
    s_waitcnt vmcnt(28)
    v_mfma_f32_32x32x16_bf16 v[16:31], v[144:147], v[148:151], v[16:31]
    v_mfma_f32_32x32x16_bf16 v[48:63], v[152:155], v[148:151], v[48:63]
    v_mfma_f32_32x32x16_bf16 v[32:47], v[144:147], v[156:159], v[32:47]
    v_mfma_f32_32x32x16_bf16 v[64:79], v[152:155], v[156:159], v[64:79]
    s_nop 1
    s_mov_b32 s19, 28672
    buffer_load_dwordx4 v[144:147], v8, s[4:7], s19 offen offset:0
    buffer_load_dwordx4 v[148:151], v10, s[4:7], s19 offen offset:0
    buffer_load_dwordx4 v[152:155], v9, s[4:7], s19 offen offset:0
    buffer_load_dwordx4 v[156:159], v11, s[4:7], s19 offen offset:0
    s_waitcnt vmcnt(28)
    v_mfma_f32_32x32x16_bf16 v[16:31], v[160:163], v[164:167], v[16:31]
    v_mfma_f32_32x32x16_bf16 v[48:63], v[168:171], v[164:167], v[48:63]
    v_mfma_f32_32x32x16_bf16 v[32:47], v[160:163], v[172:175], v[32:47]
    v_mfma_f32_32x32x16_bf16 v[64:79], v[168:171], v[172:175], v[64:79]
    s_nop 1
    buffer_load_dwordx4 v[160:163], v8, s[4:7], s19 offen offset:1024
    buffer_load_dwordx4 v[164:167], v10, s[4:7], s19 offen offset:1024
    buffer_load_dwordx4 v[168:171], v9, s[4:7], s19 offen offset:1024
    buffer_load_dwordx4 v[172:175], v11, s[4:7], s19 offen offset:1024
    s_waitcnt vmcnt(28)
    v_mfma_f32_32x32x16_bf16 v[16:31], v[176:179], v[180:183], v[16:31]
    v_mfma_f32_32x32x16_bf16 v[48:63], v[184:187], v[180:183], v[48:63]
    v_mfma_f32_32x32x16_bf16 v[32:47], v[176:179], v[188:191], v[32:47]
    v_mfma_f32_32x32x16_bf16 v[64:79], v[184:187], v[188:191], v[64:79]
    s_nop 1
    buffer_load_dwordx4 v[176:179], v8, s[4:7], s19 offen offset:2048
    buffer_load_dwordx4 v[180:183], v10, s[4:7], s19 offen offset:2048
    buffer_load_dwordx4 v[184:187], v9, s[4:7], s19 offen offset:2048
    buffer_load_dwordx4 v[188:191], v11, s[4:7], s19 offen offset:2048
    s_waitcnt vmcnt(28)
    v_mfma_f32_32x32x16_bf16 v[16:31], v[192:195], v[196:199], v[16:31]
    v_mfma_f32_32x32x16_bf16 v[48:63], v[200:203], v[196:199], v[48:63]
    v_mfma_f32_32x32x16_bf16 v[32:47], v[192:195], v[204:207], v[32:47]
    v_mfma_f32_32x32x16_bf16 v[64:79], v[200:203], v[204:207], v[64:79]
    s_nop 1
    buffer_load_dwordx4 v[192:195], v8, s[4:7], s19 offen offset:3072
    buffer_load_dwordx4 v[196:199], v10, s[4:7], s19 offen offset:3072
    buffer_load_dwordx4 v[200:203], v9, s[4:7], s19 offen offset:3072
    buffer_load_dwordx4 v[204:207], v11, s[4:7], s19 offen offset:3072
    s_waitcnt vmcnt(28)
    v_mfma_f32_32x32x16_bf16 v[16:31], v[80:83], v[84:87], v[16:31]
    v_mfma_f32_32x32x16_bf16 v[48:63], v[88:91], v[84:87], v[48:63]
    v_mfma_f32_32x32x16_bf16 v[32:47], v[80:83], v[92:95], v[32:47]
    v_mfma_f32_32x32x16_bf16 v[64:79], v[88:91], v[92:95], v[64:79]
    s_waitcnt vmcnt(24)
    v_mfma_f32_32x32x16_bf16 v[16:31], v[96:99], v[100:103], v[16:31]
    v_mfma_f32_32x32x16_bf16 v[48:63], v[104:107], v[100:103], v[48:63]
    v_mfma_f32_32x32x16_bf16 v[32:47], v[96:99], v[108:111], v[32:47]
    v_mfma_f32_32x32x16_bf16 v[64:79], v[104:107], v[108:111], v[64:79]
    s_waitcnt vmcnt(20)
    v_mfma_f32_32x32x16_bf16 v[16:31], v[112:115], v[116:119], v[16:31]
    v_mfma_f32_32x32x16_bf16 v[48:63], v[120:123], v[116:119], v[48:63]
    v_mfma_f32_32x32x16_bf16 v[32:47], v[112:115], v[124:127], v[32:47]
    v_mfma_f32_32x32x16_bf16 v[64:79], v[120:123], v[124:127], v[64:79]
    s_waitcnt vmcnt(16)
    v_mfma_f32_32x32x16_bf16 v[16:31], v[128:131], v[132:135], v[16:31]
    v_mfma_f32_32x32x16_bf16 v[48:63], v[136:139], v[132:135], v[48:63]
    v_mfma_f32_32x32x16_bf16 v[32:47], v[128:131], v[140:143], v[32:47]
    v_mfma_f32_32x32x16_bf16 v[64:79], v[136:139], v[140:143], v[64:79]
    s_waitcnt vmcnt(12)
    v_mfma_f32_32x32x16_bf16 v[16:31], v[144:147], v[148:151], v[16:31]
    v_mfma_f32_32x32x16_bf16 v[48:63], v[152:155], v[148:151], v[48:63]
    v_mfma_f32_32x32x16_bf16 v[32:47], v[144:147], v[156:159], v[32:47]
    v_mfma_f32_32x32x16_bf16 v[64:79], v[152:155], v[156:159], v[64:79]
    s_waitcnt vmcnt(8)
    v_mfma_f32_32x32x16_bf16 v[16:31], v[160:163], v[164:167], v[16:31]
    v_mfma_f32_32x32x16_bf16 v[48:63], v[168:171], v[164:167], v[48:63]
    v_mfma_f32_32x32x16_bf16 v[32:47], v[160:163], v[172:175], v[32:47]
    v_mfma_f32_32x32x16_bf16 v[64:79], v[168:171], v[172:175], v[64:79]
    s_waitcnt vmcnt(4)
    v_mfma_f32_32x32x16_bf16 v[16:31], v[176:179], v[180:183], v[16:31]
    v_mfma_f32_32x32x16_bf16 v[48:63], v[184:187], v[180:183], v[48:63]
    v_mfma_f32_32x32x16_bf16 v[32:47], v[176:179], v[188:191], v[32:47]
    v_mfma_f32_32x32x16_bf16 v[64:79], v[184:187], v[188:191], v[64:79]
    s_waitcnt vmcnt(0)
    v_mfma_f32_32x32x16_bf16 v[16:31], v[192:195], v[196:199], v[16:31]
    v_mfma_f32_32x32x16_bf16 v[48:63], v[200:203], v[196:199], v[48:63]
    v_mfma_f32_32x32x16_bf16 v[32:47], v[192:195], v[204:207], v[32:47]
    v_mfma_f32_32x32x16_bf16 v[64:79], v[200:203], v[204:207], v[64:79]
    s_nop 8
    ds_write_b128 v13, v[16:19] offset:0
    ds_write_b128 v13, v[20:23] offset:1024
    ds_write_b128 v13, v[24:27] offset:2048
    ds_write_b128 v13, v[28:31] offset:3072
    ds_write_b128 v13, v[32:35] offset:4096
    ds_write_b128 v13, v[36:39] offset:5120
    ds_write_b128 v13, v[40:43] offset:6144
    ds_write_b128 v13, v[44:47] offset:7168
    ds_write_b128 v13, v[48:51] offset:8192
    ds_write_b128 v13, v[52:55] offset:9216
    ds_write_b128 v13, v[56:59] offset:10240
    ds_write_b128 v13, v[60:63] offset:11264
    ds_write_b128 v13, v[64:67] offset:12288
    ds_write_b128 v13, v[68:71] offset:13312
    ds_write_b128 v13, v[72:75] offset:14336
    ds_write_b128 v13, v[76:79] offset:15360
    s_waitcnt lgkmcnt(0)
    s_barrier
    ds_read_b128 v[80:83], v14 offset:0
    ds_read_b128 v[84:87], v14 offset:1024
    ds_read_b128 v[88:91], v14 offset:16384
    ds_read_b128 v[92:95], v14 offset:17408
    ds_read_b128 v[96:99], v14 offset:32768
    ds_read_b128 v[100:103], v14 offset:33792
    ds_read_b128 v[104:107], v14 offset:49152
    ds_read_b128 v[108:111], v14 offset:50176
    v_add_u32 v14, 0x10000, v14
    ds_read_b128 v[112:115], v14 offset:0
    ds_read_b128 v[116:119], v14 offset:1024
    ds_read_b128 v[120:123], v14 offset:16384
    ds_read_b128 v[124:127], v14 offset:17408
    ds_read_b128 v[128:131], v14 offset:32768
    ds_read_b128 v[132:135], v14 offset:33792
    ds_read_b128 v[136:139], v14 offset:49152
    ds_read_b128 v[140:143], v14 offset:50176
    s_waitcnt lgkmcnt(0)
    v_add_f32 v80, v80, v88
    v_add_f32 v96, v96, v104
    v_add_f32 v112, v112, v120
    v_add_f32 v128, v128, v136
    v_add_f32 v81, v81, v89
    v_add_f32 v97, v97, v105
    v_add_f32 v113, v113, v121
    v_add_f32 v129, v129, v137
    v_add_f32 v82, v82, v90
    v_add_f32 v98, v98, v106
    v_add_f32 v114, v114, v122
    v_add_f32 v130, v130, v138
    v_add_f32 v83, v83, v91
    v_add_f32 v99, v99, v107
    v_add_f32 v115, v115, v123
    v_add_f32 v131, v131, v139
    v_add_f32 v84, v84, v92
    v_add_f32 v100, v100, v108
    v_add_f32 v116, v116, v124
    v_add_f32 v132, v132, v140
    v_add_f32 v85, v85, v93
    v_add_f32 v101, v101, v109
    v_add_f32 v117, v117, v125
    v_add_f32 v133, v133, v141
    v_add_f32 v86, v86, v94
    v_add_f32 v102, v102, v110
    v_add_f32 v118, v118, v126
    v_add_f32 v134, v134, v142
    v_add_f32 v87, v87, v95
    v_add_f32 v103, v103, v111
    v_add_f32 v119, v119, v127
    v_add_f32 v135, v135, v143
    v_add_f32 v80, v80, v96
    v_add_f32 v112, v112, v128
    v_add_f32 v81, v81, v97
    v_add_f32 v113, v113, v129
    v_add_f32 v82, v82, v98
    v_add_f32 v114, v114, v130
    v_add_f32 v83, v83, v99
    v_add_f32 v115, v115, v131
    v_add_f32 v84, v84, v100
    v_add_f32 v116, v116, v132
    v_add_f32 v85, v85, v101
    v_add_f32 v117, v117, v133
    v_add_f32 v86, v86, v102
    v_add_f32 v118, v118, v134
    v_add_f32 v87, v87, v103
    v_add_f32 v119, v119, v135
    v_add_f32 v80, v80, v112
    v_add_f32 v81, v81, v113
    v_add_f32 v82, v82, v114
    v_add_f32 v83, v83, v115
    v_add_f32 v84, v84, v116
    v_add_f32 v85, v85, v117
    v_add_f32 v86, v86, v118
    v_add_f32 v87, v87, v119
    v_cvt_pk_bf16_f32 v144, v80, v81
    v_cvt_pk_bf16_f32 v145, v82, v83
    v_cvt_pk_bf16_f32 v146, v84, v85
    v_cvt_pk_bf16_f32 v147, v86, v87
    s_nop 0
    v_permlane32_swap_b32 v144, v146
    v_permlane32_swap_b32 v145, v147
    buffer_store_dwordx4 v[144:147], v12, s[12:15], 0 offen
    s_waitcnt vmcnt(0)
K2_done:
    s_endpgm
.section .rodata,"a"
.p2align 6
.amdhsa_kernel attn_kernel
  .amdhsa_next_free_vgpr 256
  .amdhsa_next_free_sgpr 96
  .amdhsa_accum_offset 256
  .amdhsa_group_segment_fixed_size 0
  .amdhsa_kernarg_size 64
  .amdhsa_user_sgpr_count 2
  .amdhsa_user_sgpr_kernarg_segment_ptr 1
  .amdhsa_system_sgpr_workgroup_id_x 1
.end_amdhsa_kernel
.p2align 6
.amdhsa_kernel oproj_kernel
  .amdhsa_next_free_vgpr 208
  .amdhsa_next_free_sgpr 96
  .amdhsa_accum_offset 208
  .amdhsa_group_segment_fixed_size 0
  .amdhsa_kernarg_size 64
  .amdhsa_user_sgpr_count 2
  .amdhsa_user_sgpr_kernarg_segment_ptr 1
  .amdhsa_system_sgpr_workgroup_id_x 1
.end_amdhsa_kernel
```
